```python
import torch

def _softmax(x, axis=-1):
    return torch.softmax(x, dim=axis)
def _gelu(x):
    return torch.nn.functional.gelu(x, approximate="tanh")
def _silu(x):
    return torch.nn.functional.silu(x)
def _sigmoid(x):
    return torch.sigmoid(x)
def _layernorm(x, axis=-1, eps=1e-5):
    m = x.mean(dim=axis, keepdim=True)
    v = x.var(dim=axis, keepdim=True, unbiased=False)
    return (x - m) / torch.sqrt(v + eps)
def _scatter_add(tgt, idx, src, axis=0):
    return tgt.clone().index_add_(axis, idx, src)
def _segment_sum(src, seg, n):
    out = torch.zeros((n,) + src.shape[1:], dtype=src.dtype)
    return out.index_add_(0, seg, src)
def _pad(x, pw):
    flat = tuple(v for pair in reversed(pw) for v in pair)
    return torch.nn.functional.pad(x, flat)

kernel_name = 'gather_scatter__edge_featured_mpnn_gatedgcn__graph'

def setup_inputs():

    _w = (lambda a: (lambda t: t.to(torch.bfloat16) if t.is_floating_point() else t)(torch.as_tensor(a)))
    N, deg, D, De = 25000, 32, 64, max(0, 1)
    E = N * deg
    return {
        "x": _w((lambda *s: torch.randn(*s, dtype=torch.bfloat16) * 0.8)(N, D)),
        "e_attr": _w((lambda *s: torch.randn(*s, dtype=torch.bfloat16) * 0.8)(E, De)),
        "src": _w((lambda lo, hi, *s: torch.randint(lo, hi, s))(0, N, E).to(torch.int64)),
        "dst": _w((lambda lo, hi, *s: torch.randint(lo, hi, s))(0, N, E).to(torch.int64)),
        "w_a": _w((lambda *s: torch.randn(*s, dtype=torch.bfloat16) * 0.8)(D, D)),
        "w_b": _w((lambda *s: torch.randn(*s, dtype=torch.bfloat16) * 0.8)(D, D)),
        "w_c": _w((lambda *s: torch.randn(*s, dtype=torch.bfloat16) * 0.8)(De, D)),
        "w_u": _w((lambda *s: torch.randn(*s, dtype=torch.bfloat16) * 0.05)(D, D)),
        "w_v": _w((lambda *s: torch.randn(*s, dtype=torch.bfloat16) * 0.05)(D, D)),
    }

def reference(x, e_attr, src, dst, w_a, w_b, w_c, w_u, w_v):
    N, D = x.shape
    hv = x @ w_v
    g = x[dst] @ w_a + x[src] @ w_b + e_attr @ w_c
    eta = _sigmoid(g)
    denom = _segment_sum(eta, dst, N) + 1e-6
    eta_n = eta / denom[dst]
    agg = _segment_sum(eta_n * hv[src], dst, N)
    z = x @ w_u + agg
    relu_z = torch.where(z > 0, z, 0 * z)
    return x + relu_z
```

```asm
; @launch kernel=gs_part_kernel grid=(256,1,1) block=(896,1,1) lds=26112
; @launch kernel=gs_main_kernel grid=(256,1,1) block=(512,1,1) lds=157184
.amdgcn_target "amdgcn-amd-amdhsa--gfx950"
.text
.p2align 8
.globl gs_part_kernel
.type gs_part_kernel,@function
gs_part_kernel:
    s_cmp_ge_u32 s2, 256
    s_cbranch_scc1 K1_END
    s_load_dwordx4 s[4:7], s[0:1], 8
    s_load_dwordx2 s[8:9], s[0:1], 24
    s_load_dwordx2 s[10:11], s[0:1], 88
    s_load_dwordx2 s[44:45], s[0:1], 0
    v_lshrrev_b32 v1, 6, v0
    s_mul_i32 s12, s2, 12544
    v_readfirstlane_b32 s3, v1
    s_lshr_b32 s13, s12, 1
    v_lshlrev_b32 v2, 4, v0
    v_add_u32 v2, s12, v2
    s_cmp_eq_u32 s3, 13
    s_cbranch_scc1 K1_FRAG
    v_lshlrev_b32 v3, 3, v0
    v_add_u32 v3, s13, v3
    s_waitcnt lgkmcnt(0)
    s_mov_b32 s20, s8
    s_and_b32 s21, s9, 0xffff
    s_mov_b32 s22, 3200000
    s_mov_b32 s23, 0x20000
    buffer_load_dwordx4 v[4:7], v2, s[20:23], 0 offen
    s_mov_b32 s24, s6
    s_and_b32 s25, s7, 0xffff
    s_mov_b32 s26, 3200000
    s_mov_b32 s27, 0x20000
    s_mov_b32 s28, s4
    s_and_b32 s29, s5, 0xffff
    s_mov_b32 s30, 1600000
    s_mov_b32 s31, 0x20000
    v_lshlrev_b32 v14, 2, v0
    v_mov_b32 v15, 0
    v_cmp_gt_u32 vcc, 256, v0
    s_and_saveexec_b64 s[18:19], vcc
    ds_write_b32 v14, v15 offset:0
    s_mov_b64 exec, s[18:19]
    v_cmp_gt_u32 vcc, 784, v0
    s_mov_b32 s14, 3200000
    v_cmp_gt_u32 s[16:17], s14, v2
    s_and_b64 s[16:17], s[16:17], vcc
    s_mul_i32 s15, s2, 25088
    s_add_u32 s32, s10, s15
    s_addc_u32 s33, s11, 0
    s_and_b32 s33, s33, 0xffff
    s_mov_b32 s34, 25088
    s_mov_b32 s35, 0x20000
    s_add_u32 s36, s10, 7340032
    s_addc_u32 s37, s11, 0
    s_and_b32 s37, s37, 0xffff
    s_mov_b32 s38, 524288
    s_mov_b32 s39, 0x20000
    s_mov_b32 s40, 43980466
    s_movk_i32 s41, 3125
    v_mov_b32 v15, 1
    s_waitcnt lgkmcnt(0)
    s_barrier
    s_waitcnt vmcnt(0)
    buffer_load_dwordx4 v[8:11], v2, s[24:27], 0 offen
    buffer_load_dwordx2 v[12:13], v3, s[28:31], 0 offen
    s_and_b32 s46, s2, 7
    s_lshr_b32 s47, s2, 3
    s_lshl_b32 s46, s46, 5
    s_add_u32 s46, s46, s47
    s_mul_i32 s46, s46, 3125
    s_add_u32 s46, s46, 31
    s_lshr_b32 s46, s46, 5
    s_lshl_b32 s46, s46, 7
    s_and_b32 s45, s45, 0xffff
    s_mov_b32 s48, s44
    s_mov_b32 s49, s45
    s_mov_b32 s50, 3200000
    s_mov_b32 s51, 0x20000
    v_lshlrev_b32 v40, 4, v0
    buffer_load_dwordx4 v[56:59], v40, s[48:51], s46 offen
    s_mov_b64 exec, s[16:17]
    s_cbranch_execz K1_NOEDGE1
    v_mul_hi_u32 v16, v4, s40
    v_mul_hi_u32 v17, v5, s40
    v_mul_hi_u32 v18, v6, s40
    v_mul_hi_u32 v19, v7, s40
    v_lshlrev_b32 v20, 2, v16
    ds_add_rtn_u32 v24, v20, v15 offset:0
    v_lshlrev_b32 v21, 2, v17
    ds_add_rtn_u32 v25, v21, v15 offset:0
    v_lshlrev_b32 v22, 2, v18
    ds_add_rtn_u32 v26, v22, v15 offset:0
    v_lshlrev_b32 v23, 2, v19
    ds_add_rtn_u32 v27, v23, v15 offset:0
    v_mul_u32_u24 v28, s41, v16
    v_add_u32 v28, 31, v28
    v_lshrrev_b32 v28, 5, v28
    v_sub_u32 v28, v4, v28
    v_lshlrev_b32 v33, 2, v28
    v_mul_u32_u24 v29, s41, v17
    v_add_u32 v29, 31, v29
    v_lshrrev_b32 v29, 5, v29
    v_sub_u32 v29, v5, v29
    v_lshlrev_b32 v35, 2, v29
    v_mul_u32_u24 v30, s41, v18
    v_add_u32 v30, 31, v30
    v_lshrrev_b32 v30, 5, v30
    v_sub_u32 v30, v6, v30
    v_lshlrev_b32 v37, 2, v30
    v_mul_u32_u24 v31, s41, v19
    v_add_u32 v31, 31, v31
    v_lshrrev_b32 v31, 5, v31
    v_sub_u32 v31, v7, v31
    v_lshlrev_b32 v39, 2, v31
K1_NOEDGE1:
    s_mov_b64 exec, -1
    s_waitcnt lgkmcnt(0)
    s_barrier
    s_cmp_lg_u32 s3, 0
    s_cbranch_scc1 K1_SCANDONE
    v_lshlrev_b32 v40, 4, v0
    ds_read_b128 v[44:47], v40 offset:0
    s_waitcnt lgkmcnt(0)
    v_add_u32 v48, v44, v45
    v_add_u32 v49, v48, v46
    v_add_u32 v50, v49, v47
    v_mov_b32 v51, v50
    s_nop 1
    v_add_u32_dpp v51, v51, v51 row_shr:1 row_mask:0xf bank_mask:0xf
    s_nop 1
    v_add_u32_dpp v51, v51, v51 row_shr:2 row_mask:0xf bank_mask:0xf
    s_nop 1
    v_add_u32_dpp v51, v51, v51 row_shr:4 row_mask:0xf bank_mask:0xf
    s_nop 1
    v_add_u32_dpp v51, v51, v51 row_shr:8 row_mask:0xf bank_mask:0xf
    s_nop 1
    v_add_u32_dpp v51, v51, v51 row_bcast:15 row_mask:0xa bank_mask:0xf
    s_nop 1
    v_add_u32_dpp v51, v51, v51 row_bcast:31 row_mask:0xc bank_mask:0xf
    v_sub_u32 v52, v51, v50
    v_add_u32 v53, v52, v44
    v_add_u32 v54, v52, v48
    v_add_u32 v55, v52, v49
    ds_write_b128 v40, v[52:55] offset:0
    s_mul_i32 s15, s2, 3136
    v_min_u32 v48, 0xff, v44
    v_add_u32 v52, s15, v52
    v_lshl_or_b32 v48, v48, 24, v52
    v_min_u32 v49, 0xff, v45
    v_add_u32 v53, s15, v53
    v_lshl_or_b32 v49, v49, 24, v53
    v_min_u32 v50, 0xff, v46
    v_add_u32 v54, s15, v54
    v_lshl_or_b32 v50, v50, 24, v54
    v_min_u32 v51, 0xff, v47
    v_add_u32 v55, s15, v55
    v_lshl_or_b32 v51, v51, 24, v55
    s_lshl_b32 s15, s2, 10
    buffer_store_dwordx4 v[48:51], v40, s[36:39], s15 offen sc1
K1_SCANDONE:
    s_waitcnt lgkmcnt(0)
    s_barrier
    s_mov_b64 exec, s[16:17]
    s_cbranch_execz K1_NOEDGE2
    ds_read_b32 v28, v20 offset:0
    ds_read_b32 v29, v21 offset:0
    ds_read_b32 v30, v22 offset:0
    ds_read_b32 v31, v23 offset:0
    s_cmp_eq_u32 s3, 0
    s_cbranch_scc1 K1_W0
    s_waitcnt vmcnt(1)
    s_branch K1_HAVE
K1_W0:
    s_waitcnt vmcnt(2)
K1_HAVE:
    s_mov_b32 s42, 0xffff0000
    v_lshl_or_b32 v32, v12, 16, v8
    v_and_or_b32 v34, v12, s42, v9
    v_lshl_or_b32 v36, v13, 16, v10
    v_and_or_b32 v38, v13, s42, v11
    s_waitcnt lgkmcnt(3)
    v_add_lshl_u32 v28, v28, v24, 3
    ds_write_b64 v28, v[32:33] offset:1024
    s_waitcnt lgkmcnt(3)
    v_add_lshl_u32 v29, v29, v25, 3
    ds_write_b64 v29, v[34:35] offset:1024
    s_waitcnt lgkmcnt(3)
    v_add_lshl_u32 v30, v30, v26, 3
    ds_write_b64 v30, v[36:37] offset:1024
    s_waitcnt lgkmcnt(3)
    v_add_lshl_u32 v31, v31, v27, 3
    ds_write_b64 v31, v[38:39] offset:1024
K1_NOEDGE2:
    s_mov_b64 exec, -1
    v_lshlrev_b32 v2, 4, v0
    v_add_u32 v3, 12544, v2
    v_cmp_gt_u32 vcc, 784, v0
    s_waitcnt lgkmcnt(0)
    s_barrier
    s_and_saveexec_b64 s[18:19], vcc
    s_cbranch_execz K1_END
    ds_read_b128 v[4:7], v2 offset:1024
    ds_read_b128 v[8:11], v2 offset:13568
    s_waitcnt lgkmcnt(1)
    buffer_store_dwordx4 v[4:7], v2, s[32:35], 0 offen sc1
    s_waitcnt lgkmcnt(0)
    buffer_store_dwordx4 v[8:11], v3, s[32:35], 0 offen sc1
    s_waitcnt vmcnt(0)
    s_endpgm
K1_FRAG:
    s_cmp_ge_u32 s2, 32
    s_cbranch_scc1 K1_END
    s_barrier
    s_load_dwordx4 s[12:15], s[0:1], 32
    s_load_dwordx4 s[16:19], s[0:1], 56
    s_lshr_b32 s20, s2, 3
    s_waitcnt lgkmcnt(0)
    s_mov_b32 s22, s14
    s_mov_b32 s23, s15
    s_cmp_eq_u32 s20, 1
    s_cselect_b32 s22, s18, s22
    s_cselect_b32 s23, s19, s23
    s_cmp_eq_u32 s20, 2
    s_cselect_b32 s22, s12, s22
    s_cselect_b32 s23, s13, s23
    s_cmp_eq_u32 s20, 3
    s_cselect_b32 s22, s16, s22
    s_cselect_b32 s23, s17, s23
    s_mov_b32 s24, s22
    s_and_b32 s25, s23, 0xffff
    s_mov_b32 s26, 8192
    s_mov_b32 s27, 0x20000
    s_add_u32 s28, s10, 7864320
    s_addc_u32 s29, s11, 0
    s_and_b32 s29, s29, 0xffff
    s_mov_b32 s30, 32768
    s_mov_b32 s31, 0x20000
    s_and_b32 s32, s2, 3
    s_lshr_b32 s33, s2, 2
    s_and_b32 s33, s33, 1
    s_lshl_b32 s32, s32, 11
    s_lshl_b32 s33, s33, 6
    s_add_u32 s32, s32, s33
    v_and_b32 v1, 63, v0
    v_and_b32 v2, 31, v1
    v_lshlrev_b32 v2, 1, v2
    v_lshrrev_b32 v3, 5, v1
    v_lshlrev_b32 v3, 10, v3
    v_add3_u32 v2, v2, v3, s32
    buffer_load_ushort v8, v2, s[24:27], 0 offen offset:0
    buffer_load_ushort v9, v2, s[24:27], 0 offen offset:128
    buffer_load_ushort v10, v2, s[24:27], 0 offen offset:256
    buffer_load_ushort v11, v2, s[24:27], 0 offen offset:384
    buffer_load_ushort v12, v2, s[24:27], 0 offen offset:512
    buffer_load_ushort v13, v2, s[24:27], 0 offen offset:640
    buffer_load_ushort v14, v2, s[24:27], 0 offen offset:768
    buffer_load_ushort v15, v2, s[24:27], 0 offen offset:896
    s_mov_b32 s34, 1.0
    s_and_b32 s36, s20, 1
    s_cmp_eq_u32 s36, 0
    s_cselect_b32 s34, 0xbfb8aa3b, s34
    s_waitcnt vmcnt(0)
    v_lshlrev_b32 v8, 16, v8
    v_mul_f32 v8, s34, v8
    v_lshlrev_b32 v9, 16, v9
    v_mul_f32 v9, s34, v9
    v_lshlrev_b32 v10, 16, v10
    v_mul_f32 v10, s34, v10
    v_lshlrev_b32 v11, 16, v11
    v_mul_f32 v11, s34, v11
    v_lshlrev_b32 v12, 16, v12
    v_mul_f32 v12, s34, v12
    v_lshlrev_b32 v13, 16, v13
    v_mul_f32 v13, s34, v13
    v_lshlrev_b32 v14, 16, v14
    v_mul_f32 v14, s34, v14
    v_lshlrev_b32 v15, 16, v15
    v_mul_f32 v15, s34, v15
    v_cvt_pk_bf16_f32 v16, v8, v9
    v_cvt_pk_bf16_f32 v17, v10, v11
    v_cvt_pk_bf16_f32 v18, v12, v13
    v_cvt_pk_bf16_f32 v19, v14, v15
    v_lshlrev_b32 v4, 4, v1
    s_lshl_b32 s35, s2, 10
    v_add_u32 v4, s35, v4
    buffer_store_dwordx4 v[16:19], v4, s[28:31], 0 offen
    s_waitcnt vmcnt(0)
K1_END:
    s_endpgm
.p2align 8
.globl gs_main_kernel
.type gs_main_kernel,@function
gs_main_kernel:
    s_cmp_ge_u32 s2, 256
    s_cbranch_scc1 K2_END
    s_load_dwordx2 s[10:11], s[0:1], 88
    s_load_dwordx2 s[4:5], s[0:1], 0
    s_load_dwordx2 s[6:7], s[0:1], 48
    s_load_dwordx2 s[8:9], s[0:1], 72
    s_and_b32 s3, s2, 7
    s_lshr_b32 s2, s2, 3
    s_lshl_b32 s3, s3, 5
    s_add_u32 s2, s2, s3
    v_lshrrev_b32 v227, 6, v0
    v_and_b32 v1, 63, v0
    v_readfirstlane_b32 s28, v227
    v_lshrrev_b32 v244, 5, v1
    s_lshl_b32 s49, s28, 1
    v_add_u32 v244, s49, v244
    v_lshrrev_b32 v230, 3, v1
    v_lshlrev_b32 v230, 12, v230
    s_lshl_b32 s49, s28, 15
    v_add_u32 v230, s49, v230
    v_lshlrev_b32 v227, 4, v1
    s_mul_i32 s49, s2, 3125
    s_add_u32 s29, s49, 31
    s_lshr_b32 s29, s29, 5
    s_add_u32 s49, s49, 3156
    s_lshr_b32 s49, s49, 5
    s_sub_u32 s30, s49, s29
    s_lshl_b32 s58, s28, 12
    s_add_u32 s58, s58, 124416
    v_bfe_u32 v231, v1, 4, 1
    v_and_b32 v232, 7, v1
    v_xor_b32 v231, v231, v232
    v_lshlrev_b32 v231, 4, v231
    v_add_u32 v212, 4096, v231
    v_xor_b32 v232, 32, v231
    v_add_u32 v213, 3072, v232
    v_xor_b32 v232, 64, v231
    v_add_u32 v214, 2048, v232
    v_xor_b32 v232, 96, v231
    v_add_u32 v215, 1024, v232
    v_bfe_u32 v245, v1, 3, 2
    v_lshrrev_b32 v232, 5, v1
    v_lshlrev_b32 v231, 3, v245
    v_lshl_add_u32 v231, v232, 2, v231
    s_lshr_b32 s49, s28, 1
    s_lshl_b32 s50, s49, 5
    s_add_u32 s50, s50, s29
    s_and_b32 s52, s28, 1
    s_lshl_b32 s52, s52, 1
    s_add_u32 s50, s50, s52
    v_add_u32 v231, s50, v231
    v_lshlrev_b32 v231, 7, v231
    s_cmp_eq_u32 s52, 0
    s_cbranch_scc0 K2_XI2
    v_add_u32 v234, v231, v212
    v_add_u32 v235, v231, v213
    s_branch K2_XI
K2_XI2:
    v_add_u32 v234, v231, v214
    v_add_u32 v235, v231, v215
    v_add_u32 v234, 2048, v234
    v_add_u32 v235, 2048, v235
K2_XI:
    v_add_u32 v235, 128, v235
    v_and_b32 v220, 31, v1
    s_lshl_b32 s50, s2, 2
    s_add_u32 s50, s50, 7340032
    s_waitcnt lgkmcnt(0)
    s_add_u32 s16, s10, s50
    s_addc_u32 s17, s11, 0
    s_and_b32 s17, s17, 0xffff
    s_mov_b32 s18, 262144
    s_mov_b32 s19, 0x20000
    buffer_load_dword v132, v230, s[16:19], 0 offen
    buffer_load_dword v133, v230, s[16:19], 0 offen offset:1024
    buffer_load_dword v134, v230, s[16:19], 0 offen offset:2048
    buffer_load_dword v135, v230, s[16:19], 0 offen offset:3072
    s_sub_u32 s12, s4, 4096
    s_subb_u32 s13, s5, 0
    s_and_b32 s13, s13, 0xffff
    s_mov_b32 s14, 3204096
    s_mov_b32 s15, 0x20000
    s_add_u32 s24, s10, 7864320
    s_addc_u32 s25, s11, 0
    s_and_b32 s25, s25, 0xffff
    s_mov_b32 s26, 32768
    s_mov_b32 s27, 0x20000
    s_lshr_b32 s49, s28, 1
    s_lshl_b32 s49, s49, 12
    s_and_b32 s52, s28, 1
    s_lshl_b32 s52, s52, 11
    s_add_u32 s49, s49, s52
    s_add_u32 s49, s49, 124416
    s_mov_b32 m0, s49
    v_lshlrev_b32 v227, 4, v1
    buffer_load_dwordx4 v234, s[12:15], 0 offen lds
    buffer_load_dwordx4 v235, s[12:15], 0 offen offset:1024 lds
    s_lshl_b32 s49, s28, 11
    s_add_u32 s50, s49, 140800
    s_mov_b32 m0, s50
    s_add_u32 s52, s49, 16384
    buffer_load_dwordx4 v227, s[24:27], s52 offen lds
    buffer_load_dwordx4 v227, s[24:27], s52 offen offset:1024 lds
    s_add_u32 s50, s49, 108032
    s_mov_b32 m0, s50
    s_nop 0
    buffer_load_dwordx4 v227, s[24:27], s49 offen lds
    buffer_load_dwordx4 v227, s[24:27], s49 offen offset:1024 lds
    s_mov_b32 s20, s6
    s_and_b32 s21, s7, 0xffff
    s_mov_b32 s22, 128
    s_mov_b32 s23, 0x20000
    v_lshlrev_b32 v231, 1, v220
    buffer_load_ushort v2, v231, s[20:23], 0 offen
    buffer_load_ushort v3, v231, s[20:23], 0 offen offset:64
    v_lshlrev_b32 v231, 4, v0
    v_mov_b32 v240, 0xffff
    v_mov_b32 v241, 0xffff
    v_mov_b64 v[242:243], v[240:241]
    ds_write_b128 v231, v[240:243] offset:5376
    s_cmp_ge_u32 s28, 7
    s_cbranch_scc1 K2_I10
    ds_write_b128 v231, v[240:243] offset:13568
K2_I10:
    v_mov_b32 v240, 97568
    v_mov_b32 v241, 97568
    v_mov_b64 v[242:243], v[240:241]
    v_cmp_gt_u32 vcc, 240, v0
    s_and_saveexec_b64 s[54:55], vcc
    ds_write_b128 v231, v[240:243] offset:1536
    s_mov_b64 exec, s[54:55]
    s_cmp_lg_u32 s28, 0
    s_cbranch_scc1 K2_I20
    v_mov_b64 v[240:241], 0
    v_mov_b64 v[242:243], 0
    ds_write_b128 v231, v[240:243] offset:0
    v_add_u32 v231, 98080, v231
    s_mov_b64 exec, 0xff
    ds_write_b128 v231, v[240:243]
    s_mov_b64 exec, -1
K2_I20:
    v_and_b32 v231, 3, v1
    v_lshlrev_b32 v247, 2, v231
    v_lshl_add_u32 v208, v231, 3, v245
    v_lshrrev_b32 v232, 1, v245
    v_lshl_add_u32 v231, v231, 1, v232
    v_bfe_u32 v232, v1, 2, 1
    s_lshl_b32 s49, s28, 1
    v_add_u32 v246, s49, v232
    v_lshl_add_u32 v208, v232, 2, v208
    v_lshrrev_b32 v233, 5, v1
    v_cmp_eq_u32 vcc, v232, v233
    v_xor_b32 v231, v231, v233
    v_lshlrev_b32 v231, 4, v231
    v_lshl_add_u32 v208, v208, 7, v231
    v_mov_b32 v232, 0x3f80
    v_cndmask_b32 v232, 0, v232, vcc
    v_mov_b32 v233, 1
    v_lshlrev_b32 v233, v245, v233
    v_bfe_u32 v231, v233, 0, 1
    v_mul_u32_u24 v180, v231, v232
    v_lshlrev_b32 v184, 16, v180
    v_bfe_u32 v231, v233, 1, 1
    v_mul_u32_u24 v181, v231, v232
    v_lshlrev_b32 v185, 16, v181
    v_bfe_u32 v231, v233, 2, 1
    v_mul_u32_u24 v182, v231, v232
    v_lshlrev_b32 v186, 16, v182
    v_bfe_u32 v231, v233, 3, 1
    v_mul_u32_u24 v183, v231, v232
    v_lshlrev_b32 v187, 16, v183
    v_cmp_gt_u32 vcc, 32, v1
    v_mov_b32 v231, 0x0a0c0100
    v_mov_b32 v232, 0x07060100
    v_cndmask_b32 v221, v231, v232, vcc
    v_mov_b32 v231, 0x03020a0c
    v_mov_b32 v232, 0x03020706
    v_cndmask_b32 v222, v231, v232, vcc
    s_mov_b32 s38, 0x26800000
    s_mov_b32 s39, 0x26800000
    s_mov_b32 s46, 128
    s_mov_b32 s47, 0xffff
    s_mov_b32 s48, 0xffff0000
    v_and_b32 v228, 7, v1
    v_lshlrev_b32 v228, 4, v228
    v_lshlrev_b32 v220, 2, v220
    s_waitcnt vmcnt(0) lgkmcnt(0)
    s_barrier
    s_mov_b32 s20, s10
    s_and_b32 s21, s11, 0xffff
    s_mov_b32 s22, 6422528
    s_mov_b32 s23, 0x20000
    v_lshrrev_b32 v229, 3, v228
    v_cmp_gt_u32_sdwa s[60:61], v132, v229 src0_sel:BYTE_3 src1_sel:DWORD
    v_cmp_gt_u32_sdwa s[64:65], v133, v229 src0_sel:BYTE_3 src1_sel:DWORD
    v_cmp_gt_u32_sdwa s[68:69], v134, v229 src0_sel:BYTE_3 src1_sel:DWORD
    v_cmp_gt_u32_sdwa s[72:73], v135, v229 src0_sel:BYTE_3 src1_sel:DWORD
    v_add_u32 v230, 1, v229
    v_cmp_gt_u32_sdwa s[62:63], v132, v230 src0_sel:BYTE_3 src1_sel:DWORD
    v_cmp_gt_u32_sdwa s[66:67], v133, v230 src0_sel:BYTE_3 src1_sel:DWORD
    v_cmp_gt_u32_sdwa s[70:71], v134, v230 src0_sel:BYTE_3 src1_sel:DWORD
    v_cmp_gt_u32_sdwa s[74:75], v135, v230 src0_sel:BYTE_3 src1_sel:DWORD
    v_add_u32 v230, 16, v229
    v_cmp_gt_u32_sdwa s[76:77], v132, v230 src0_sel:BYTE_3 src1_sel:DWORD
    v_cmp_gt_u32_sdwa s[80:81], v133, v230 src0_sel:BYTE_3 src1_sel:DWORD
    v_cmp_gt_u32_sdwa s[84:85], v134, v230 src0_sel:BYTE_3 src1_sel:DWORD
    v_cmp_gt_u32_sdwa s[88:89], v135, v230 src0_sel:BYTE_3 src1_sel:DWORD
    v_add_u32 v230, 17, v229
    v_cmp_gt_u32_sdwa s[78:79], v132, v230 src0_sel:BYTE_3 src1_sel:DWORD
    v_cmp_gt_u32_sdwa s[82:83], v133, v230 src0_sel:BYTE_3 src1_sel:DWORD
    v_cmp_gt_u32_sdwa s[86:87], v134, v230 src0_sel:BYTE_3 src1_sel:DWORD
    v_cmp_gt_u32_sdwa s[90:91], v135, v230 src0_sel:BYTE_3 src1_sel:DWORD
    v_mad_u32_u24 v116, v132, 8, v228
    v_mad_u32_u24 v117, v133, 8, v228
    v_mad_u32_u24 v118, v134, 8, v228
    v_mad_u32_u24 v119, v135, 8, v228
    s_mov_b64 exec, s[60:61]
    buffer_load_dwordx4 v[148:151], v116, s[20:23], 0 offen
    s_mov_b64 exec, s[64:65]
    buffer_load_dwordx4 v[152:155], v117, s[20:23], 0 offen
    s_mov_b64 exec, s[68:69]
    buffer_load_dwordx4 v[156:159], v118, s[20:23], 0 offen
    s_mov_b64 exec, s[72:73]
    buffer_load_dwordx4 v[160:163], v119, s[20:23], 0 offen
    s_mov_b64 exec, s[76:77]
    s_cbranch_execz L_skl_1
    buffer_load_dwordx4 v[164:167], v116, s[20:23], 0 offen offset:128
L_skl_1:
    s_mov_b64 exec, s[80:81]
    s_cbranch_execz L_skl_2
    buffer_load_dwordx4 v[168:171], v117, s[20:23], 0 offen offset:128
L_skl_2:
    s_mov_b64 exec, s[84:85]
    s_cbranch_execz L_skl_3
    buffer_load_dwordx4 v[172:175], v118, s[20:23], 0 offen offset:128
L_skl_3:
    s_mov_b64 exec, s[88:89]
    s_cbranch_execz L_skl_4
    buffer_load_dwordx4 v[176:179], v119, s[20:23], 0 offen offset:128
L_skl_4:
    s_mov_b64 exec, -1
    v_max3_u32 v230, v132, v133, v134
    v_max_u32 v230, v230, v135
    v_lshrrev_b32 v230, 24, v230
    v_cmp_lt_u32 s[56:57], 32, v230
    s_mov_b64 s[92:93], 0
    s_mov_b64 s[94:95], 0
    s_cmp_lg_u64 s[56:57], 0
    s_cbranch_scc1 K2_CSEL
K2_CBACK:
    s_mov_b64 exec, s[56:57]
    v_mov_b32 v230, 508
    v_mov_b32 v231, 1
    ds_write_b32 v230, v231
    s_mov_b64 exec, -1
    s_lshr_b32 s49, s28, 1
    s_lshl_b32 s50, s49, 12
    s_add_u32 s50, s50, 124416
    v_add_u32 v227, s50, v208
    v_xor_b32 v228, 32, v227
    ds_read_b128 v[68:71], v227
    ds_read_b128 v[72:75], v228
    v_xor_b32 v228, 64, v227
    v_xor_b32 v229, 96, v227
    ds_read_b128 v[76:79], v228
    ds_read_b128 v[80:83], v229
    s_and_b32 s52, s28, 1
    s_lshl_b32 s53, s52, 13
    s_add_u32 s53, s53, 140800
    v_lshlrev_b32 v249, 4, v1
    v_add_u32 v249, s53, v249
    ds_read_b128 v[132:135], v249 offset:0
    ds_read_b128 v[136:139], v249 offset:1024
    ds_read_b128 v[140:143], v249 offset:2048
    ds_read_b128 v[144:147], v249 offset:3072
    ds_read_b128 v[116:119], v249 offset:4096
    ds_read_b128 v[120:123], v249 offset:5120
    ds_read_b128 v[124:127], v249 offset:6144
    ds_read_b128 v[128:131], v249 offset:7168
    s_mul_i32 s50, s49, 25088
    s_lshl_b32 s53, s52, 7
    s_add_u32 s50, s50, s53
    s_add_u32 s50, s50, 21248
    v_lshrrev_b32 v250, 5, v1
    v_mul_u32_u24 v250, 3136, v250
    v_add3_u32 v250, v250, v220, s50
    s_waitcnt lgkmcnt(0)
    v_mfma_f32_32x32x16_bf16 v[84:99], v[68:71], v[132:135], 0
    v_mfma_f32_32x32x16_bf16 v[100:115], v[68:71], v[116:119], 0
    v_mfma_f32_32x32x16_bf16 v[84:99], v[72:75], v[136:139], v[84:99]
    v_mfma_f32_32x32x16_bf16 v[100:115], v[72:75], v[120:123], v[100:115]
    v_mfma_f32_32x32x16_bf16 v[84:99], v[76:79], v[140:143], v[84:99]
    v_mfma_f32_32x32x16_bf16 v[100:115], v[76:79], v[124:127], v[100:115]
    v_mfma_f32_32x32x16_bf16 v[84:99], v[80:83], v[144:147], v[84:99]
    v_mfma_f32_32x32x16_bf16 v[100:115], v[80:83], v[128:131], v[100:115]
    s_nop 7
    s_nop 3
    s_cmp_lg_u32 s28, 0
    s_cbranch_scc1 K2_NOCI
    v_mul_u32_u24 v227, 1568, v1
    v_mov_b32 v228, 512
    v_add_u32 v227, 20736, v227
    s_mov_b32 exec_hi, 131071
    ds_write_b32 v227, v228 offset:768
    ds_write_b32 v227, v228 offset:1552
    s_mov_b64 exec, -1
K2_NOCI:
    v_cvt_pk_bf16_f32 v84, v84, v100
    v_cvt_pk_bf16_f32 v85, v85, v101
    v_cvt_pk_bf16_f32 v86, v86, v102
    v_cvt_pk_bf16_f32 v87, v87, v103
    v_cvt_pk_bf16_f32 v88, v88, v104
    v_cvt_pk_bf16_f32 v89, v89, v105
    v_cvt_pk_bf16_f32 v90, v90, v106
    v_cvt_pk_bf16_f32 v91, v91, v107
    v_cvt_pk_bf16_f32 v92, v92, v108
    v_cvt_pk_bf16_f32 v93, v93, v109
    v_cvt_pk_bf16_f32 v94, v94, v110
    v_cvt_pk_bf16_f32 v95, v95, v111
    v_cvt_pk_bf16_f32 v96, v96, v112
    v_cvt_pk_bf16_f32 v97, v97, v113
    v_cvt_pk_bf16_f32 v98, v98, v114
    v_cvt_pk_bf16_f32 v99, v99, v115
    s_lshr_b32 s49, s28, 1
    s_cmp_eq_u32 s49, 3
    s_cbranch_scc1 K2_RT3F
    ds_write_b32 v250, v84 offset:0
    ds_write_b32 v250, v85 offset:784
    ds_write_b32 v250, v86 offset:1568
    ds_write_b32 v250, v87 offset:2352
    ds_write_b32 v250, v88 offset:6272
    ds_write_b32 v250, v89 offset:7056
    ds_write_b32 v250, v90 offset:7840
    ds_write_b32 v250, v91 offset:8624
    ds_write_b32 v250, v92 offset:12544
    ds_write_b32 v250, v93 offset:13328
    ds_write_b32 v250, v94 offset:14112
    ds_write_b32 v250, v95 offset:14896
    s_waitcnt lgkmcnt(8)
    ds_write_b32 v250, v96 offset:18816
    ds_write_b32 v250, v97 offset:19600
    ds_write_b32 v250, v98 offset:20384
    ds_write_b32 v250, v99 offset:21168
    s_branch K2_RTDF
K2_RT3F:
    s_mov_b32 exec_hi, 0
    ds_write_b32 v250, v84 offset:0
    ds_write_b32 v250, v85 offset:784
    s_mov_b64 exec, -1
K2_RTDF:
    s_waitcnt vmcnt(0) lgkmcnt(0)
    v_mov_b32 v231, 1
    s_mov_b64 exec, s[60:61]
    ds_add_rtn_u32 v116, v149, v231 offset:0
    s_mov_b64 exec, s[62:63]
    ds_add_rtn_u32 v117, v151, v231 offset:0
    s_mov_b64 exec, s[64:65]
    ds_add_rtn_u32 v118, v153, v231 offset:0
    s_mov_b64 exec, s[66:67]
    ds_add_rtn_u32 v119, v155, v231 offset:0
    s_mov_b64 exec, s[68:69]
    ds_add_rtn_u32 v120, v157, v231 offset:0
    s_mov_b64 exec, s[70:71]
    ds_add_rtn_u32 v121, v159, v231 offset:0
    s_mov_b64 exec, s[72:73]
    ds_add_rtn_u32 v122, v161, v231 offset:0
    s_mov_b64 exec, s[74:75]
    ds_add_rtn_u32 v123, v163, v231 offset:0
    s_waitcnt lgkmcnt(6)
    s_mov_b64 exec, s[76:77]
    s_cbranch_execz L_skh_5
    ds_add_rtn_u32 v124, v165, v231 offset:0
    s_mov_b64 exec, s[78:79]
    ds_add_rtn_u32 v125, v167, v231 offset:0
L_skh_5:
    s_mov_b64 exec, s[80:81]
    s_cbranch_execz L_skh_6
    ds_add_rtn_u32 v126, v169, v231 offset:0
    s_mov_b64 exec, s[82:83]
    ds_add_rtn_u32 v127, v171, v231 offset:0
L_skh_6:
    s_mov_b64 exec, s[84:85]
    s_cbranch_execz L_skh_7
    ds_add_rtn_u32 v128, v173, v231 offset:0
    s_mov_b64 exec, s[86:87]
    ds_add_rtn_u32 v129, v175, v231 offset:0
L_skh_7:
    s_mov_b64 exec, s[88:89]
    s_cbranch_execz L_skh_8
    ds_add_rtn_u32 v130, v177, v231 offset:0
    s_mov_b64 exec, s[90:91]
    ds_add_rtn_u32 v131, v179, v231 offset:0
L_skh_8:
    s_mov_b64 exec, s[92:93]
    s_cbranch_execz L_skhc_9
    s_waitcnt lgkmcnt(6)
    ds_add_rtn_u32 v225, v253, v231 offset:0
    s_mov_b64 exec, s[94:95]
    ds_add_rtn_u32 v226, v255, v231 offset:0
L_skhc_9:
    s_mov_b64 exec, -1
    s_waitcnt lgkmcnt(0)
    s_barrier
    v_lshlrev_b32 v227, 3, v1
    ds_read_b64 v[236:237], v227 offset:0
    v_mul_u32_u24 v200, 1568, v1
    v_add_u32 v200, 20736, v200
    s_waitcnt lgkmcnt(0)
    v_add_u32 v231, 3, v236
    v_add_u32 v232, 3, v237
    v_and_b32 v231, -4, v231
    v_and_b32 v232, -4, v232
    v_add_u32 v229, v231, v232
    v_max_u32 v228, v231, v232
    v_mov_b32 v230, v229
    s_nop 1
    v_add_u32_dpp v230, v230, v230 row_shr:1 row_mask:0xf bank_mask:0xf
    s_nop 1
    v_add_u32_dpp v230, v230, v230 row_shr:2 row_mask:0xf bank_mask:0xf
    s_nop 1
    v_add_u32_dpp v230, v230, v230 row_shr:4 row_mask:0xf bank_mask:0xf
    s_nop 1
    v_add_u32_dpp v230, v230, v230 row_shr:8 row_mask:0xf bank_mask:0xf
    s_nop 1
    v_add_u32_dpp v230, v230, v230 row_bcast:15 row_mask:0xa bank_mask:0xf
    s_nop 1
    v_add_u32_dpp v230, v230, v230 row_bcast:31 row_mask:0xc bank_mask:0xf
    v_sub_u32 v196, v230, v229
    v_readlane_b32 s50, v230, 63
    v_add_u32 v197, v196, v231
    v_lshlrev_b32 v238, 2, v196
    v_lshlrev_b32 v239, 2, v197
    ds_write_b64 v227, v[238:239] offset:1024
    v_mov_b32 v198, v197
    v_add_u32 v199, v197, v232
    s_add_u32 s50, s50, 127
    s_lshr_b32 s50, s50, 7
    s_lshr_b32 s49, s50, 1
    s_sub_u32 s50, s50, s49
    s_lshl_b32 s35, s50, 2
    s_lshl_b32 s36, s49, 2
    s_sub_u32 s37, s35, s36
    s_lshl_b32 s37, s37, 3
    s_cmp_lt_u32 s28, 4
    s_cselect_b32 s33, s35, s36
    s_cselect_b32 s37, 0, s37
    s_lshr_b32 s34, s33, 2
    s_sub_u32 s34, s34, 1
    v_readlane_b32 s49, v237, 63
    s_cmp_eq_u32 s36, 0
    s_cselect_b32 s50, s35, s36
    s_lshl_b32 s50, s50, 2
    v_cmp_lt_u32 vcc, s50, v228
    s_cmp_lg_u32 s49, 0
    s_cbranch_scc1 K2_SLOW
    s_add_u32 s50, s35, s36
    s_cmp_gt_u32 s50, 119
    s_cbranch_scc1 K2_SLOW
    s_cbranch_vccnz K2_SLOW
    s_waitcnt lgkmcnt(0)
    s_mov_b64 exec, s[60:61]
    ds_read_b32 v68, v149 offset:1024
    s_mov_b64 exec, s[62:63]
    ds_read_b32 v69, v151 offset:1024
    s_mov_b64 exec, s[64:65]
    ds_read_b32 v70, v153 offset:1024
    s_mov_b64 exec, s[66:67]
    ds_read_b32 v71, v155 offset:1024
    s_mov_b64 exec, s[68:69]
    ds_read_b32 v72, v157 offset:1024
    s_mov_b64 exec, s[70:71]
    ds_read_b32 v73, v159 offset:1024
    s_mov_b64 exec, s[72:73]
    ds_read_b32 v74, v161 offset:1024
    s_mov_b64 exec, s[74:75]
    ds_read_b32 v75, v163 offset:1024
    s_mov_b64 exec, s[60:61]
    s_waitcnt lgkmcnt(7)
    v_lshl_add_u32 v68, v116, 2, v68
    ds_write_b32 v68, v148 offset:5376
    s_mov_b64 exec, s[62:63]
    s_waitcnt lgkmcnt(7)
    v_lshl_add_u32 v69, v117, 2, v69
    ds_write_b32 v69, v150 offset:5376
    s_mov_b64 exec, s[64:65]
    s_waitcnt lgkmcnt(7)
    v_lshl_add_u32 v70, v118, 2, v70
    ds_write_b32 v70, v152 offset:5376
    s_mov_b64 exec, s[66:67]
    s_waitcnt lgkmcnt(7)
    v_lshl_add_u32 v71, v119, 2, v71
    ds_write_b32 v71, v154 offset:5376
    s_mov_b64 exec, s[68:69]
    s_waitcnt lgkmcnt(7)
    v_lshl_add_u32 v72, v120, 2, v72
    ds_write_b32 v72, v156 offset:5376
    s_mov_b64 exec, s[70:71]
    s_waitcnt lgkmcnt(7)
    v_lshl_add_u32 v73, v121, 2, v73
    ds_write_b32 v73, v158 offset:5376
    s_mov_b64 exec, s[72:73]
    s_waitcnt lgkmcnt(7)
    v_lshl_add_u32 v74, v122, 2, v74
    ds_write_b32 v74, v160 offset:5376
    s_mov_b64 exec, s[74:75]
    s_waitcnt lgkmcnt(7)
    v_lshl_add_u32 v75, v123, 2, v75
    ds_write_b32 v75, v162 offset:5376
    s_mov_b64 exec, s[76:77]
    s_cbranch_execz L_sks_10
    ds_read_b32 v76, v165 offset:1024
    s_mov_b64 exec, s[78:79]
    ds_read_b32 v77, v167 offset:1024
    s_waitcnt lgkmcnt(0)
    v_lshl_add_u32 v77, v125, 2, v77
    ds_write_b32 v77, v166 offset:5376
    s_mov_b64 exec, s[76:77]
    v_lshl_add_u32 v76, v124, 2, v76
    ds_write_b32 v76, v164 offset:5376
L_sks_10:
    s_mov_b64 exec, s[80:81]
    s_cbranch_execz L_sks_11
    ds_read_b32 v78, v169 offset:1024
    s_mov_b64 exec, s[82:83]
    ds_read_b32 v79, v171 offset:1024
    s_waitcnt lgkmcnt(0)
    v_lshl_add_u32 v79, v127, 2, v79
    ds_write_b32 v79, v170 offset:5376
    s_mov_b64 exec, s[80:81]
    v_lshl_add_u32 v78, v126, 2, v78
    ds_write_b32 v78, v168 offset:5376
L_sks_11:
    s_mov_b64 exec, s[84:85]
    s_cbranch_execz L_sks_12
    ds_read_b32 v80, v173 offset:1024
    s_mov_b64 exec, s[86:87]
    ds_read_b32 v81, v175 offset:1024
    s_waitcnt lgkmcnt(0)
    v_lshl_add_u32 v81, v129, 2, v81
    ds_write_b32 v81, v174 offset:5376
    s_mov_b64 exec, s[84:85]
    v_lshl_add_u32 v80, v128, 2, v80
    ds_write_b32 v80, v172 offset:5376
L_sks_12:
    s_mov_b64 exec, s[88:89]
    s_cbranch_execz L_sks_13
    ds_read_b32 v82, v177 offset:1024
    s_mov_b64 exec, s[90:91]
    ds_read_b32 v83, v179 offset:1024
    s_waitcnt lgkmcnt(0)
    v_lshl_add_u32 v83, v131, 2, v83
    ds_write_b32 v83, v178 offset:5376
    s_mov_b64 exec, s[88:89]
    v_lshl_add_u32 v82, v130, 2, v82
    ds_write_b32 v82, v176 offset:5376
L_sks_13:
    s_mov_b64 exec, s[92:93]
    s_cbranch_execz L_sksc_14
    ds_read_b32 v68, v253 offset:1024
    s_mov_b64 exec, s[94:95]
    ds_read_b32 v69, v255 offset:1024
    s_waitcnt lgkmcnt(0)
    v_lshl_add_u32 v69, v226, 2, v69
    ds_write_b32 v69, v254 offset:5376
    s_mov_b64 exec, s[92:93]
    v_lshl_add_u32 v68, v225, 2, v68
    ds_write_b32 v68, v252 offset:5376
L_sksc_14:
    s_mov_b64 exec, -1
    s_waitcnt lgkmcnt(0)
    s_barrier
    s_cmp_eq_u32 s33, 0
    s_cbranch_scc1 K2_NOL
    v_add_u32 v228, s37, v245
    v_mad_u32_u24 v227, v244, s33, v228
    v_lshlrev_b32 v216, 4, v227
    ds_read_b128 v[204:207], v216 offset:5376
    v_lshlrev_b32 v219, 2, v227
    v_sub_u32 v218, v227, v245
    v_lshlrev_b32 v218, 2, v218
    v_add_u32 v218, 1536, v218
    v_mad_u32_u24 v227, v246, s33, v228
    v_lshl_add_u32 v217, v227, 4, v247
    s_mov_b32 m0, s58
    s_waitcnt lgkmcnt(0)
    v_mad_u32_u16 v204, v204, s46, v212
    v_mad_u32_u16 v205, v205, s46, v213
    v_mad_u32_u16 v206, v206, s46, v214
    v_mad_u32_u16 v207, v207, s46, v215
    buffer_load_dwordx4 v204, s[12:15], 0 offen lds
    buffer_load_dwordx4 v205, s[12:15], 0 offen offset:1024 lds
    buffer_load_dwordx4 v206, s[12:15], 0 offen offset:2048 lds
    buffer_load_dwordx4 v207, s[12:15], 0 offen offset:3072 lds
K2_NOL:
    v_cmp_gt_u32 vcc, 49, v1
    v_lshl_or_b32 v228, v1, 1, 1
    v_cmp_le_u32 s[54:55], s30, v228
    v_mov_b32 v229, 1
    s_nop 0
    v_cndmask_b32 v228, v237, v229, s[54:55]
    v_min_u32 v228, v236, v228
    v_cmp_eq_u32 s[54:55], 0, v228
    s_and_b64 s[54:55], s[54:55], vcc
    s_cbranch_scc1 K2_ZROWS
K2_ZBACK:
    v_max_u32 v240, v231, v232
    v_cvt_f32_u32 v227, s35
    v_cvt_f32_u32 v230, s36
    v_rcp_f32 v227, v227
    v_rcp_f32 v230, v230
    s_lshl_b32 s49, s35, 5
    s_sub_u32 s50, s35, s36
    s_lshl_b32 s50, s50, 5
    v_mul_f32 v227, 0.25, v227
    v_mul_f32 v230, 0.25, v230
    v_cmp_gt_u32 vcc, s49, v196
    v_subrev_u32 v233, s50, v196
    s_nop 0
    v_cndmask_b32 v233, v233, v196, vcc
    v_cndmask_b32 v234, v230, v227, vcc
    v_cvt_f32_u32 v233, v233
    v_add_f32 v233, 2.0, v233
    v_mul_f32 v233, v234, v233
    v_cvt_u32_f32 v228, v233
    v_add_u32 v228, 1, v228
    v_mov_b32 v233, s36
    v_mov_b32 v234, s35
    v_cndmask_b32 v233, v233, v234, vcc
    v_mov_b32 v234, s50
    v_cndmask_b32 v234, v234, 0, vcc
    v_lshlrev_b32 v233, 2, v233
    v_mad_u32_u24 v238, v228, v233, v234
    v_cmp_gt_u32 vcc, s49, v197
    v_subrev_u32 v233, s50, v197
    s_nop 0
    v_cndmask_b32 v233, v233, v197, vcc
    v_cndmask_b32 v234, v230, v227, vcc
    v_cvt_f32_u32 v233, v233
    v_add_f32 v233, 2.0, v233
    v_mul_f32 v233, v234, v233
    v_cvt_u32_f32 v229, v233
    v_add_u32 v229, 1, v229
    v_mov_b32 v233, s36
    v_mov_b32 v234, s35
    v_cndmask_b32 v233, v233, v234, vcc
    v_mov_b32 v234, s50
    v_cndmask_b32 v234, v234, 0, vcc
    v_lshlrev_b32 v233, 2, v233
    v_mad_u32_u24 v239, v229, v233, v234
    s_movk_i32 s50, 640
    v_mov_b32 v230, 97568
    v_mad_u32_u24 v241, v228, s50, v230
    v_mad_u32_u24 v242, v229, s50, v230
    v_add_u32 v230, 784, v200
    v_lshrrev_b32 v233, 1, v228
    v_cmp_lt_u32 vcc, v238, v198
    v_cmp_eq_u32 s[54:55], s28, v233
    s_and_b64 vcc, vcc, s[54:55]
    s_cbranch_scc0 L_nosplit_15
L_splitlp_16:
    s_ff1_i32_b64 s49, vcc
    s_bitset0_b64 vcc, s49
    v_readlane_b32 s52, v200, s49
    v_readlane_b32 s53, v241, s49
    v_lshrrev_b32 v233, 0, v220
    s_mov_b32 exec_hi, 0
    v_add_u32 v234, s52, v233
    ds_read_b32 v235, v234 offset:512
    v_add_u32 v234, s53, v233
    v_mov_b32 v233, s52
    v_mov_b32 v227, s53
    ds_write_b32 v233, v227 offset:768
    s_waitcnt lgkmcnt(1)
    ds_write_b32 v234, v235 offset:512
    s_mov_b64 exec, -1
    s_cmp_lg_u64 vcc, 0
    s_cbranch_scc1 L_splitlp_16
L_nosplit_15:
    v_lshrrev_b32 v233, 1, v229
    v_cmp_lt_u32 vcc, v239, v199
    v_cmp_eq_u32 s[54:55], s28, v233
    s_and_b64 vcc, vcc, s[54:55]
    s_cbranch_scc0 L_nosplit_17
L_splitlp_18:
    s_ff1_i32_b64 s49, vcc
    s_bitset0_b64 vcc, s49
    v_readlane_b32 s52, v230, s49
    v_readlane_b32 s53, v242, s49
    v_lshrrev_b32 v233, 0, v220
    s_mov_b32 exec_hi, 0
    v_add_u32 v234, s52, v233
    ds_read_b32 v235, v234 offset:512
    v_add_u32 v234, s53, v233
    v_mov_b32 v233, s52
    v_mov_b32 v227, s53
    ds_write_b32 v233, v227 offset:768
    s_waitcnt lgkmcnt(1)
    ds_write_b32 v234, v235 offset:512
    s_mov_b64 exec, -1
    s_cmp_lg_u64 vcc, 0
    s_cbranch_scc1 L_splitlp_18
L_nosplit_17:
    s_lshl_b32 s49, s28, 2
    v_add_u32 v227, s49, v196
    v_add_u32 v228, s49, v197
    v_add_u32 v229, 784, v200
K2_QFF:
    s_add_u32 s50, s49, 4
    v_cmp_eq_u32 s[54:55], s50, v231
    v_cmp_eq_u32 s[56:57], s50, v232
    v_add_u32 v233, 4, v227
    v_add_u32 v234, 4, v228
    v_cmp_eq_u32 vcc, v233, v238
    s_or_b64 s[54:55], s[54:55], vcc
    v_cmp_eq_u32 vcc, v234, v239
    s_or_b64 s[56:57], s[56:57], vcc
    v_cmp_ge_u32 vcc, v227, v238
    s_nop 1
    v_cndmask_b32 v233, v200, v241, vcc
    v_cmp_ge_u32 vcc, v228, v239
    s_nop 1
    v_cndmask_b32 v234, v229, v242, vcc
    v_or_b32 v230, 0x80000000, v233
    v_or_b32 v235, 0x80000000, v234
    v_cmp_lt_u32 vcc, s49, v231
    v_cndmask_b32 v233, v233, v230, s[54:55]
    v_cndmask_b32 v234, v234, v235, s[56:57]
    v_cmp_lt_u32 s[54:55], s49, v232
    s_mov_b64 exec, vcc
    ds_write_b32 v227, v233 offset:1536
    s_mov_b64 exec, s[54:55]
    ds_write_b32 v228, v234 offset:1536
    s_mov_b64 exec, -1
    s_add_u32 s49, s49, 32
    v_add_u32 v227, 32, v227
    v_add_u32 v228, 32, v228
    v_cmp_lt_u32 vcc, s49, v240
    s_cbranch_vccnz K2_QFF
    v_lshlrev_b32 v249, 4, v1
    v_add_u32 v249, 108032, v249
    ds_read_b128 v[4:7], v249 offset:0
    ds_read_b128 v[8:11], v249 offset:1024
    ds_read_b128 v[12:15], v249 offset:2048
    ds_read_b128 v[16:19], v249 offset:3072
    ds_read_b128 v[20:23], v249 offset:4096
    ds_read_b128 v[24:27], v249 offset:5120
    ds_read_b128 v[28:31], v249 offset:6144
    ds_read_b128 v[32:35], v249 offset:7168
    ds_read_b128 v[36:39], v249 offset:8192
    ds_read_b128 v[40:43], v249 offset:9216
    ds_read_b128 v[44:47], v249 offset:10240
    ds_read_b128 v[48:51], v249 offset:11264
    s_waitcnt lgkmcnt(8)
    ds_read_b128 v[52:55], v249 offset:12288
    ds_read_b128 v[56:59], v249 offset:13312
    ds_read_b128 v[60:63], v249 offset:14336
    ds_read_b128 v[64:67], v249 offset:15360
    v_add_u32 v208, s58, v208
    v_xor_b32 v209, 32, v208
    v_xor_b32 v210, 64, v208
    v_xor_b32 v211, 96, v208
    s_mov_b32 s53, 0xbfb8aa3b
    v_lshlrev_b32 v2, 16, v2
    v_mul_f32 v2, s53, v2
    v_lshlrev_b32 v3, 16, v3
    v_mul_f32 v3, s53, v3
    v_cvt_pk_bf16_f32 v2, 0, v2
    v_cvt_pk_bf16_f32 v3, v3, 0
    v_cmp_gt_u32 vcc, 32, v1
    v_mov_b32 v233, 0xb2000000
    v_mov_b32 v234, 0xb200
    v_cndmask_b32 v2, v233, v2, vcc
    v_cndmask_b32 v3, v234, v3, vcc
    s_waitcnt lgkmcnt(0)
    s_barrier
    s_cmp_eq_u32 s33, 0
    s_cbranch_scc1 K2_EPI
    ds_read_b128 v[196:199], v218
    ds_read_b32 v224, v219 offset:1536
    ds_read_b32 v223, v217 offset:5376
    ds_read_b128 v[204:207], v216 offset:5440
    v_mov_b64 v[172:173], 0
    v_mov_b64 v[176:177], 0
    v_mov_b64 v[174:175], 0
    v_mov_b64 v[178:179], 0
    v_mov_b32 v148, 1.0
    v_mov_b32 v228, 1.0
    v_mov_b32 v149, 1.0
    v_mov_b32 v229, 1.0
    v_mov_b32 v150, 1.0
    v_mov_b32 v230, 1.0
    v_mov_b32 v151, 1.0
    v_mov_b32 v231, 1.0
    v_mov_b32 v152, 1.0
    v_mov_b32 v232, 1.0
    v_mov_b32 v153, 1.0
    v_mov_b32 v233, 1.0
    v_mov_b32 v154, 1.0
    v_mov_b32 v234, 1.0
    v_mov_b32 v155, 1.0
    v_mov_b32 v235, 1.0
    v_mov_b64 v[156:157], 0
    v_mov_b64 v[164:165], 0
    v_mov_b64 v[236:237], 0
    v_mov_b64 v[244:245], 0
    v_mov_b64 v[158:159], 0
    v_mov_b64 v[166:167], 0
    v_mov_b64 v[238:239], 0
    v_mov_b64 v[246:247], 0
    v_mov_b64 v[160:161], 0
    v_mov_b64 v[168:169], 0
    v_mov_b64 v[240:241], 0
    v_mov_b64 v[248:249], 0
    v_mov_b64 v[162:163], 0
    v_mov_b64 v[170:171], 0
    v_mov_b64 v[242:243], 0
    v_mov_b64 v[250:251], 0
    s_mov_b32 s45, 0
    s_waitcnt lgkmcnt(0)
    v_mad_u32_u24 v196, v196, 1, v220
    v_mad_u32_u24 v197, v197, 1, v220
    v_mad_u32_u24 v198, v198, 1, v220
    v_mad_u32_u24 v199, v199, 1, v220
    ds_read_b32 v192, v196 offset:512
    ds_read_b32 v189, v197 offset:512
    ds_read_b32 v190, v198 offset:512
    ds_read_b32 v191, v199 offset:512
    v_perm_b32 v180, v223, v180, v221
    v_perm_b32 v184, v223, v184, v222
    v_cmp_gt_i32 s[40:41], 0, v224
    v_mad_u32_u16 v204, v204, s46, v212
    v_mad_u32_u16 v205, v205, s46, v213
    v_mad_u32_u16 v206, v206, s46, v214
    v_mad_u32_u16 v207, v207, s46, v215
    s_waitcnt vmcnt(0)
    ds_read_b128 v[68:71], v208
    ds_read_b128 v[72:75], v209
    ds_read_b128 v[76:79], v210
    ds_read_b128 v[80:83], v211
    s_or_b32 s44, s40, s41
    s_waitcnt lgkmcnt(0)
    v_and_or_b32 v188, v192, s47, v2
    buffer_load_dwordx4 v204, s[12:15], 0 offen lds
    buffer_load_dwordx4 v205, s[12:15], 0 offen offset:1024 lds
    buffer_load_dwordx4 v206, s[12:15], 0 offen offset:2048 lds
    buffer_load_dwordx4 v207, s[12:15], 0 offen offset:3072 lds
    ds_read_b128 v[204:207], v216 offset:5504
    v_mfma_f32_32x32x16_bf16 v[100:115], v[68:71], v[36:39], 0
    v_mfma_f32_32x32x16_bf16 v[84:99], v[68:71], v[4:7], 0
    v_mfma_f32_32x32x16_bf16 v[100:115], v[72:75], v[40:43], v[100:115]
    v_mfma_f32_32x32x16_bf16 v[84:99], v[72:75], v[8:11], v[84:99]
    v_mfma_f32_32x32x16_bf16 v[100:115], v[76:79], v[44:47], v[100:115]
    v_mfma_f32_32x32x16_bf16 v[84:99], v[76:79], v[12:15], v[84:99]
    v_mfma_f32_32x32x16_bf16 v[100:115], v[80:83], v[48:51], v[100:115]
    v_mfma_f32_32x32x16_bf16 v[84:99], v[80:83], v[16:19], v[84:99]
    v_mfma_f32_32x32x16_bf16 v[84:99], v[180:183], v[188:191], v[84:99]
    s_waitcnt lgkmcnt(0)
    s_nop 7
    s_nop 3
    s_add_u32 s49, s34, 1
    s_mul_i32 s49, s49, 20
    s_lshr_b32 s49, s49, 6
    s_lshl_b32 s49, s49, 1
    s_sub_u32 s59, s34, s49
    s_cmp_ge_u32 s28, 4
    s_cbranch_scc0 K2_PR0F
    s_setprio 1
K2_PR0F:
K2_T0F:
    s_cmp_eq_u32 s34, s59
    s_cbranch_scc1 K2_SWPF
K2_SWBF:
    v_mfma_f32_32x32x16_bf16 v[132:147], v[68:71], v[52:55], 0
    v_rcp_f32 v228, v228
    ds_read_b32 v224, v219 offset:1552
    v_rcp_f32 v229, v229
    ds_read_b32 v223, v217 offset:5440
    v_rcp_f32 v230, v230
    v_mfma_f32_32x32x16_bf16 v[116:131], v[68:71], v[20:23], 0
    v_rcp_f32 v231, v231
    v_and_or_b32 v188, v192, s48, v3
    v_rcp_f32 v232, v232
    v_rcp_f32 v233, v233
    v_mfma_f32_32x32x16_bf16 v[132:147], v[72:75], v[56:59], v[132:147]
    v_rcp_f32 v234, v234
    v_mad_u32_u16 v204, v204, s46, v212
    v_rcp_f32 v235, v235
    v_exp_f32 v84, v84
    v_mfma_f32_32x32x16_bf16 v[116:131], v[72:75], v[24:27], v[116:131]
    v_exp_f32 v85, v85
    v_mad_u32_u16 v205, v205, s46, v213
    v_exp_f32 v86, v86
    v_exp_f32 v87, v87
    v_mfma_f32_32x32x16_bf16 v[132:147], v[76:79], v[60:63], v[132:147]
    v_exp_f32 v88, v88
    v_mad_u32_u16 v206, v206, s46, v214
    v_exp_f32 v89, v89
    v_exp_f32 v90, v90
    v_mfma_f32_32x32x16_bf16 v[116:131], v[76:79], v[28:31], v[116:131]
    v_exp_f32 v91, v91
    v_mad_u32_u16 v207, v207, s46, v215
    v_exp_f32 v92, v92
    v_exp_f32 v93, v93
    v_mfma_f32_32x32x16_bf16 v[132:147], v[80:83], v[64:67], v[132:147]
    v_exp_f32 v94, v94
    v_exp_f32 v95, v95
    v_mfma_f32_32x32x16_bf16 v[116:131], v[80:83], v[32:35], v[116:131]
    v_exp_f32 v96, v96
    v_exp_f32 v97, v97
    v_mfma_f32_32x32x16_bf16 v[116:131], v[184:187], v[188:191], v[116:131]
    v_exp_f32 v98, v98
    v_exp_f32 v99, v99
    s_waitcnt vmcnt(0)
    ds_read_b128 v[68:71], v208
    ds_read_b128 v[72:75], v209
    ds_read_b128 v[76:79], v210
    ds_read_b128 v[80:83], v211
    v_pk_fma_f32 v[176:177], v[148:149], v[156:157], v[176:177]
    v_pk_fma_f32 v[172:173], v[148:149], v[164:165], v[172:173]
    v_pk_fma_f32 v[178:179], v[228:229], v[236:237], v[178:179]
    v_pk_fma_f32 v[174:175], v[228:229], v[244:245], v[174:175]
    s_bitcmp1_b32 s45, 0
    s_cbranch_scc1 L_fl_19
L_bk_20:
    v_pk_fma_f32 v[176:177], v[150:151], v[158:159], v[176:177]
    v_pk_fma_f32 v[172:173], v[150:151], v[166:167], v[172:173]
    v_pk_fma_f32 v[178:179], v[230:231], v[238:239], v[178:179]
    v_pk_fma_f32 v[174:175], v[230:231], v[246:247], v[174:175]
    s_bitcmp1_b32 s45, 8
    s_cbranch_scc1 L_fl_21
L_bk_22:
    v_pk_fma_f32 v[176:177], v[152:153], v[160:161], v[176:177]
    v_pk_fma_f32 v[172:173], v[152:153], v[168:169], v[172:173]
    v_pk_fma_f32 v[178:179], v[232:233], v[240:241], v[178:179]
    v_pk_fma_f32 v[174:175], v[232:233], v[248:249], v[174:175]
    s_bitcmp1_b32 s45, 16
    s_cbranch_scc1 L_fl_23
L_bk_24:
    v_pk_fma_f32 v[176:177], v[154:155], v[162:163], v[176:177]
    v_pk_fma_f32 v[172:173], v[154:155], v[170:171], v[172:173]
    v_pk_fma_f32 v[178:179], v[234:235], v[242:243], v[178:179]
    v_pk_fma_f32 v[174:175], v[234:235], v[250:251], v[174:175]
    s_bitcmp1_b32 s45, 24
    s_cbranch_scc1 L_fl_25
L_bk_26:
    ds_read_b128 v[200:203], v218 offset:16
    v_pk_fma_f32 v[84:85], v[84:85], s[38:39], s[38:39] clamp
    v_pk_fma_f32 v[86:87], v[86:87], s[38:39], s[38:39] clamp
    v_pk_fma_f32 v[88:89], v[88:89], s[38:39], s[38:39] clamp
    v_pk_fma_f32 v[90:91], v[90:91], s[38:39], s[38:39] clamp
    v_pk_fma_f32 v[92:93], v[92:93], s[38:39], s[38:39] clamp
    v_pk_fma_f32 v[94:95], v[94:95], s[38:39], s[38:39] clamp
    v_pk_fma_f32 v[96:97], v[96:97], s[38:39], s[38:39] clamp
    v_pk_fma_f32 v[98:99], v[98:99], s[38:39], s[38:39] clamp
    v_pk_mul_f32 v[156:157], v[86:87], v[100:101]
    v_pk_mul_f32 v[148:149], v[84:85], v[86:87]
    v_pk_add_f32 v[164:165], v[84:85], v[86:87]
    v_pk_fma_f32 v[156:157], v[84:85], v[102:103], v[156:157]
    v_pk_mul_f32 v[158:159], v[90:91], v[104:105]
    v_pk_mul_f32 v[150:151], v[88:89], v[90:91]
    v_pk_add_f32 v[166:167], v[88:89], v[90:91]
    v_pk_fma_f32 v[158:159], v[88:89], v[106:107], v[158:159]
    v_pk_mul_f32 v[160:161], v[94:95], v[108:109]
    v_pk_mul_f32 v[152:153], v[92:93], v[94:95]
    v_pk_add_f32 v[168:169], v[92:93], v[94:95]
    v_pk_fma_f32 v[160:161], v[92:93], v[110:111], v[160:161]
    v_pk_mul_f32 v[162:163], v[98:99], v[112:113]
    v_pk_mul_f32 v[154:155], v[96:97], v[98:99]
    v_pk_add_f32 v[170:171], v[96:97], v[98:99]
    v_pk_fma_f32 v[162:163], v[96:97], v[114:115], v[162:163]
    s_sub_u32 s34, s34, 1
    s_cbranch_scc1 K2_E0F
    s_waitcnt lgkmcnt(0)
    v_mfma_f32_32x32x16_bf16 v[100:115], v[68:71], v[36:39], 0
    v_rcp_f32 v148, v148
    v_mad_u32_u24 v200, v200, 1, v220
    buffer_load_dwordx4 v204, s[12:15], 0 offen lds
    v_rcp_f32 v149, v149
    v_mad_u32_u24 v201, v201, 1, v220
    buffer_load_dwordx4 v205, s[12:15], 0 offen offset:1024 lds
    v_rcp_f32 v150, v150
    ds_read_b32 v192, v200 offset:512
    buffer_load_dwordx4 v206, s[12:15], 0 offen offset:2048 lds
    v_mfma_f32_32x32x16_bf16 v[84:99], v[68:71], v[4:7], 0
    v_rcp_f32 v151, v151
    v_mad_u32_u24 v202, v202, 1, v220
    ds_read_b32 v189, v201 offset:512
    buffer_load_dwordx4 v207, s[12:15], 0 offen offset:3072 lds
    v_rcp_f32 v152, v152
    v_mad_u32_u24 v203, v203, 1, v220
    ds_read_b32 v190, v202 offset:512
    v_rcp_f32 v153, v153
    ds_read_b32 v191, v203 offset:512
    v_mfma_f32_32x32x16_bf16 v[100:115], v[72:75], v[40:43], v[100:115]
    v_rcp_f32 v154, v154
    ds_read_b128 v[204:207], v216 offset:5568
    v_rcp_f32 v155, v155
    v_perm_b32 v180, v223, v180, v221
    v_exp_f32 v116, v116
    v_mfma_f32_32x32x16_bf16 v[84:99], v[72:75], v[8:11], v[84:99]
    v_exp_f32 v117, v117
    v_perm_b32 v184, v223, v184, v222
    v_exp_f32 v118, v118
    v_exp_f32 v119, v119
    v_cmp_gt_i32 s[42:43], 0, v224
    v_mfma_f32_32x32x16_bf16 v[100:115], v[76:79], v[44:47], v[100:115]
    v_exp_f32 v120, v120
    v_exp_f32 v121, v121
    v_exp_f32 v122, v122
    v_mfma_f32_32x32x16_bf16 v[84:99], v[76:79], v[12:15], v[84:99]
    v_exp_f32 v123, v123
    v_exp_f32 v124, v124
    v_exp_f32 v125, v125
    s_or_b32 s45, s42, s43
    v_mfma_f32_32x32x16_bf16 v[100:115], v[80:83], v[48:51], v[100:115]
    v_exp_f32 v126, v126
    v_exp_f32 v127, v127
    s_waitcnt lgkmcnt(0)
    v_and_or_b32 v188, v192, s47, v2
    v_mfma_f32_32x32x16_bf16 v[84:99], v[80:83], v[16:19], v[84:99]
    v_exp_f32 v128, v128
    v_exp_f32 v129, v129
    v_mfma_f32_32x32x16_bf16 v[84:99], v[180:183], v[188:191], v[84:99]
    v_exp_f32 v130, v130
    v_exp_f32 v131, v131
    v_pk_fma_f32 v[116:117], v[116:117], s[38:39], s[38:39] clamp
    v_pk_fma_f32 v[118:119], v[118:119], s[38:39], s[38:39] clamp
    v_pk_fma_f32 v[120:121], v[120:121], s[38:39], s[38:39] clamp
    v_pk_fma_f32 v[122:123], v[122:123], s[38:39], s[38:39] clamp
    v_pk_fma_f32 v[124:125], v[124:125], s[38:39], s[38:39] clamp
    v_pk_fma_f32 v[126:127], v[126:127], s[38:39], s[38:39] clamp
    v_pk_fma_f32 v[128:129], v[128:129], s[38:39], s[38:39] clamp
    v_pk_fma_f32 v[130:131], v[130:131], s[38:39], s[38:39] clamp
    v_pk_mul_f32 v[236:237], v[118:119], v[132:133]
    v_pk_mul_f32 v[228:229], v[116:117], v[118:119]
    v_pk_add_f32 v[244:245], v[116:117], v[118:119]
    v_pk_fma_f32 v[236:237], v[116:117], v[134:135], v[236:237]
    v_pk_mul_f32 v[238:239], v[122:123], v[136:137]
    v_pk_mul_f32 v[230:231], v[120:121], v[122:123]
    v_pk_add_f32 v[246:247], v[120:121], v[122:123]
    v_pk_fma_f32 v[238:239], v[120:121], v[138:139], v[238:239]
    v_pk_mul_f32 v[240:241], v[126:127], v[140:141]
    v_pk_mul_f32 v[232:233], v[124:125], v[126:127]
    v_pk_add_f32 v[248:249], v[124:125], v[126:127]
    v_pk_fma_f32 v[240:241], v[124:125], v[142:143], v[240:241]
    v_pk_mul_f32 v[242:243], v[130:131], v[144:145]
    v_pk_mul_f32 v[234:235], v[128:129], v[130:131]
    v_pk_add_f32 v[250:251], v[128:129], v[130:131]
    v_pk_fma_f32 v[242:243], v[128:129], v[146:147], v[242:243]
    v_mfma_f32_32x32x16_bf16 v[132:147], v[68:71], v[52:55], 0
    v_rcp_f32 v228, v228
    ds_read_b32 v224, v219 offset:1568
    v_rcp_f32 v229, v229
    ds_read_b32 v223, v217 offset:5504
    v_rcp_f32 v230, v230
    v_mfma_f32_32x32x16_bf16 v[116:131], v[68:71], v[20:23], 0
    v_rcp_f32 v231, v231
    v_and_or_b32 v188, v192, s48, v3
    v_rcp_f32 v232, v232
    v_rcp_f32 v233, v233
    v_mfma_f32_32x32x16_bf16 v[132:147], v[72:75], v[56:59], v[132:147]
    v_rcp_f32 v234, v234
    v_mad_u32_u16 v204, v204, s46, v212
    v_rcp_f32 v235, v235
    v_exp_f32 v84, v84
    v_mfma_f32_32x32x16_bf16 v[116:131], v[72:75], v[24:27], v[116:131]
    v_exp_f32 v85, v85
    v_mad_u32_u16 v205, v205, s46, v213
    v_exp_f32 v86, v86
    v_exp_f32 v87, v87
    v_mfma_f32_32x32x16_bf16 v[132:147], v[76:79], v[60:63], v[132:147]
    v_exp_f32 v88, v88
    v_mad_u32_u16 v206, v206, s46, v214
    v_exp_f32 v89, v89
    v_exp_f32 v90, v90
    v_mfma_f32_32x32x16_bf16 v[116:131], v[76:79], v[28:31], v[116:131]
    v_exp_f32 v91, v91
    v_mad_u32_u16 v207, v207, s46, v215
    v_exp_f32 v92, v92
    v_exp_f32 v93, v93
    v_mfma_f32_32x32x16_bf16 v[132:147], v[80:83], v[64:67], v[132:147]
    v_exp_f32 v94, v94
    v_exp_f32 v95, v95
    v_mfma_f32_32x32x16_bf16 v[116:131], v[80:83], v[32:35], v[116:131]
    v_exp_f32 v96, v96
    v_exp_f32 v97, v97
    v_mfma_f32_32x32x16_bf16 v[116:131], v[184:187], v[188:191], v[116:131]
    v_exp_f32 v98, v98
    v_exp_f32 v99, v99
    s_waitcnt vmcnt(0)
    ds_read_b128 v[68:71], v208
    ds_read_b128 v[72:75], v209
    ds_read_b128 v[76:79], v210
    ds_read_b128 v[80:83], v211
    v_pk_fma_f32 v[176:177], v[148:149], v[156:157], v[176:177]
    v_pk_fma_f32 v[172:173], v[148:149], v[164:165], v[172:173]
    v_pk_fma_f32 v[178:179], v[228:229], v[236:237], v[178:179]
    v_pk_fma_f32 v[174:175], v[228:229], v[244:245], v[174:175]
    s_bitcmp1_b32 s44, 0
    s_cbranch_scc1 L_fl_27
L_bk_28:
    v_pk_fma_f32 v[176:177], v[150:151], v[158:159], v[176:177]
    v_pk_fma_f32 v[172:173], v[150:151], v[166:167], v[172:173]
    v_pk_fma_f32 v[178:179], v[230:231], v[238:239], v[178:179]
    v_pk_fma_f32 v[174:175], v[230:231], v[246:247], v[174:175]
    s_bitcmp1_b32 s44, 8
    s_cbranch_scc1 L_fl_29
L_bk_30:
    v_pk_fma_f32 v[176:177], v[152:153], v[160:161], v[176:177]
    v_pk_fma_f32 v[172:173], v[152:153], v[168:169], v[172:173]
    v_pk_fma_f32 v[178:179], v[232:233], v[240:241], v[178:179]
    v_pk_fma_f32 v[174:175], v[232:233], v[248:249], v[174:175]
    s_bitcmp1_b32 s44, 16
    s_cbranch_scc1 L_fl_31
L_bk_32:
    v_pk_fma_f32 v[176:177], v[154:155], v[162:163], v[176:177]
    v_pk_fma_f32 v[172:173], v[154:155], v[170:171], v[172:173]
    v_pk_fma_f32 v[178:179], v[234:235], v[242:243], v[178:179]
    v_pk_fma_f32 v[174:175], v[234:235], v[250:251], v[174:175]
    s_bitcmp1_b32 s44, 24
    s_cbranch_scc1 L_fl_33
L_bk_34:
    ds_read_b128 v[196:199], v218 offset:32
    v_pk_fma_f32 v[84:85], v[84:85], s[38:39], s[38:39] clamp
    v_pk_fma_f32 v[86:87], v[86:87], s[38:39], s[38:39] clamp
    v_pk_fma_f32 v[88:89], v[88:89], s[38:39], s[38:39] clamp
    v_pk_fma_f32 v[90:91], v[90:91], s[38:39], s[38:39] clamp
    v_pk_fma_f32 v[92:93], v[92:93], s[38:39], s[38:39] clamp
    v_pk_fma_f32 v[94:95], v[94:95], s[38:39], s[38:39] clamp
    v_pk_fma_f32 v[96:97], v[96:97], s[38:39], s[38:39] clamp
    v_pk_fma_f32 v[98:99], v[98:99], s[38:39], s[38:39] clamp
    v_pk_mul_f32 v[156:157], v[86:87], v[100:101]
    v_pk_mul_f32 v[148:149], v[84:85], v[86:87]
    v_pk_add_f32 v[164:165], v[84:85], v[86:87]
    v_pk_fma_f32 v[156:157], v[84:85], v[102:103], v[156:157]
    v_pk_mul_f32 v[158:159], v[90:91], v[104:105]
    v_pk_mul_f32 v[150:151], v[88:89], v[90:91]
    v_pk_add_f32 v[166:167], v[88:89], v[90:91]
    v_pk_fma_f32 v[158:159], v[88:89], v[106:107], v[158:159]
    v_pk_mul_f32 v[160:161], v[94:95], v[108:109]
    v_pk_mul_f32 v[152:153], v[92:93], v[94:95]
    v_pk_add_f32 v[168:169], v[92:93], v[94:95]
    v_pk_fma_f32 v[160:161], v[92:93], v[110:111], v[160:161]
    v_pk_mul_f32 v[162:163], v[98:99], v[112:113]
    v_pk_mul_f32 v[154:155], v[96:97], v[98:99]
    v_pk_add_f32 v[170:171], v[96:97], v[98:99]
    v_pk_fma_f32 v[162:163], v[96:97], v[114:115], v[162:163]
    s_sub_u32 s34, s34, 1
    s_cbranch_scc1 K2_E1F
    s_waitcnt lgkmcnt(0)
    v_mfma_f32_32x32x16_bf16 v[100:115], v[68:71], v[36:39], 0
    v_rcp_f32 v148, v148
    v_mad_u32_u24 v196, v196, 1, v220
    buffer_load_dwordx4 v204, s[12:15], 0 offen lds
    v_rcp_f32 v149, v149
    v_mad_u32_u24 v197, v197, 1, v220
    buffer_load_dwordx4 v205, s[12:15], 0 offen offset:1024 lds
    v_rcp_f32 v150, v150
    ds_read_b32 v192, v196 offset:512
    buffer_load_dwordx4 v206, s[12:15], 0 offen offset:2048 lds
    v_mfma_f32_32x32x16_bf16 v[84:99], v[68:71], v[4:7], 0
    v_rcp_f32 v151, v151
    v_mad_u32_u24 v198, v198, 1, v220
    ds_read_b32 v189, v197 offset:512
    buffer_load_dwordx4 v207, s[12:15], 0 offen offset:3072 lds
    v_rcp_f32 v152, v152
    v_mad_u32_u24 v199, v199, 1, v220
    ds_read_b32 v190, v198 offset:512
    v_rcp_f32 v153, v153
    ds_read_b32 v191, v199 offset:512
    v_mfma_f32_32x32x16_bf16 v[100:115], v[72:75], v[40:43], v[100:115]
    v_rcp_f32 v154, v154
    ds_read_b128 v[204:207], v216 offset:5632
    v_rcp_f32 v155, v155
    v_perm_b32 v180, v223, v180, v221
    v_exp_f32 v116, v116
    v_mfma_f32_32x32x16_bf16 v[84:99], v[72:75], v[8:11], v[84:99]
    v_exp_f32 v117, v117
    v_perm_b32 v184, v223, v184, v222
    v_exp_f32 v118, v118
    v_exp_f32 v119, v119
    v_cmp_gt_i32 s[40:41], 0, v224
    v_mfma_f32_32x32x16_bf16 v[100:115], v[76:79], v[44:47], v[100:115]
    v_exp_f32 v120, v120
    v_exp_f32 v121, v121
    v_add_u32 v218, 32, v218
    v_exp_f32 v122, v122
    v_add_u32 v219, 32, v219
    v_mfma_f32_32x32x16_bf16 v[84:99], v[76:79], v[12:15], v[84:99]
    v_exp_f32 v123, v123
    v_add_u32 v217, 128, v217
    v_exp_f32 v124, v124
    v_add_u32 v216, 128, v216
    v_exp_f32 v125, v125
    s_or_b32 s44, s40, s41
    v_mfma_f32_32x32x16_bf16 v[100:115], v[80:83], v[48:51], v[100:115]
    v_exp_f32 v126, v126
    v_exp_f32 v127, v127
    s_waitcnt lgkmcnt(0)
    v_and_or_b32 v188, v192, s47, v2
    v_mfma_f32_32x32x16_bf16 v[84:99], v[80:83], v[16:19], v[84:99]
    v_exp_f32 v128, v128
    v_exp_f32 v129, v129
    v_mfma_f32_32x32x16_bf16 v[84:99], v[180:183], v[188:191], v[84:99]
    v_exp_f32 v130, v130
    v_exp_f32 v131, v131
    v_pk_fma_f32 v[116:117], v[116:117], s[38:39], s[38:39] clamp
    v_pk_fma_f32 v[118:119], v[118:119], s[38:39], s[38:39] clamp
    v_pk_fma_f32 v[120:121], v[120:121], s[38:39], s[38:39] clamp
    v_pk_fma_f32 v[122:123], v[122:123], s[38:39], s[38:39] clamp
    v_pk_fma_f32 v[124:125], v[124:125], s[38:39], s[38:39] clamp
    v_pk_fma_f32 v[126:127], v[126:127], s[38:39], s[38:39] clamp
    v_pk_fma_f32 v[128:129], v[128:129], s[38:39], s[38:39] clamp
    v_pk_fma_f32 v[130:131], v[130:131], s[38:39], s[38:39] clamp
    v_pk_mul_f32 v[236:237], v[118:119], v[132:133]
    v_pk_mul_f32 v[228:229], v[116:117], v[118:119]
    v_pk_add_f32 v[244:245], v[116:117], v[118:119]
    v_pk_fma_f32 v[236:237], v[116:117], v[134:135], v[236:237]
    v_pk_mul_f32 v[238:239], v[122:123], v[136:137]
    v_pk_mul_f32 v[230:231], v[120:121], v[122:123]
    v_pk_add_f32 v[246:247], v[120:121], v[122:123]
    v_pk_fma_f32 v[238:239], v[120:121], v[138:139], v[238:239]
    v_pk_mul_f32 v[240:241], v[126:127], v[140:141]
    v_pk_mul_f32 v[232:233], v[124:125], v[126:127]
    v_pk_add_f32 v[248:249], v[124:125], v[126:127]
    v_pk_fma_f32 v[240:241], v[124:125], v[142:143], v[240:241]
    v_pk_mul_f32 v[242:243], v[130:131], v[144:145]
    v_pk_mul_f32 v[234:235], v[128:129], v[130:131]
    v_pk_add_f32 v[250:251], v[128:129], v[130:131]
    v_pk_fma_f32 v[242:243], v[128:129], v[146:147], v[242:243]
    s_branch K2_T0F
K2_E0F:
    v_rcp_f32 v148, v148
    v_rcp_f32 v149, v149
    v_rcp_f32 v150, v150
    v_rcp_f32 v151, v151
    v_rcp_f32 v152, v152
    v_rcp_f32 v153, v153
    v_rcp_f32 v154, v154
    v_rcp_f32 v155, v155
    v_exp_f32 v116, v116
    v_exp_f32 v117, v117
    v_exp_f32 v118, v118
    v_exp_f32 v119, v119
    v_exp_f32 v120, v120
    v_exp_f32 v121, v121
    v_exp_f32 v122, v122
    v_exp_f32 v123, v123
    v_exp_f32 v124, v124
    v_exp_f32 v125, v125
    v_exp_f32 v126, v126
    v_exp_f32 v127, v127
    v_exp_f32 v128, v128
    v_exp_f32 v129, v129
    v_exp_f32 v130, v130
    v_exp_f32 v131, v131
    v_pk_fma_f32 v[116:117], v[116:117], s[38:39], s[38:39] clamp
    v_pk_fma_f32 v[118:119], v[118:119], s[38:39], s[38:39] clamp
    v_pk_fma_f32 v[120:121], v[120:121], s[38:39], s[38:39] clamp
    v_pk_fma_f32 v[122:123], v[122:123], s[38:39], s[38:39] clamp
    v_pk_fma_f32 v[124:125], v[124:125], s[38:39], s[38:39] clamp
    v_pk_fma_f32 v[126:127], v[126:127], s[38:39], s[38:39] clamp
    v_pk_fma_f32 v[128:129], v[128:129], s[38:39], s[38:39] clamp
    v_pk_fma_f32 v[130:131], v[130:131], s[38:39], s[38:39] clamp
    v_pk_mul_f32 v[236:237], v[118:119], v[132:133]
    v_pk_mul_f32 v[228:229], v[116:117], v[118:119]
    v_pk_add_f32 v[244:245], v[116:117], v[118:119]
    v_pk_fma_f32 v[236:237], v[116:117], v[134:135], v[236:237]
    v_pk_mul_f32 v[238:239], v[122:123], v[136:137]
    v_pk_mul_f32 v[230:231], v[120:121], v[122:123]
    v_pk_add_f32 v[246:247], v[120:121], v[122:123]
    v_pk_fma_f32 v[238:239], v[120:121], v[138:139], v[238:239]
    v_pk_mul_f32 v[240:241], v[126:127], v[140:141]
    v_pk_mul_f32 v[232:233], v[124:125], v[126:127]
    v_pk_add_f32 v[248:249], v[124:125], v[126:127]
    v_pk_fma_f32 v[240:241], v[124:125], v[142:143], v[240:241]
    v_pk_mul_f32 v[242:243], v[130:131], v[144:145]
    v_pk_mul_f32 v[234:235], v[128:129], v[130:131]
    v_pk_add_f32 v[250:251], v[128:129], v[130:131]
    v_pk_fma_f32 v[242:243], v[128:129], v[146:147], v[242:243]
    v_rcp_f32 v228, v228
    v_rcp_f32 v229, v229
    v_rcp_f32 v230, v230
    v_rcp_f32 v231, v231
    v_rcp_f32 v232, v232
    v_rcp_f32 v233, v233
    v_rcp_f32 v234, v234
    v_rcp_f32 v235, v235
    s_nop 0
    v_pk_fma_f32 v[176:177], v[148:149], v[156:157], v[176:177]
    v_pk_fma_f32 v[172:173], v[148:149], v[164:165], v[172:173]
    v_pk_fma_f32 v[178:179], v[228:229], v[236:237], v[178:179]
    v_pk_fma_f32 v[174:175], v[228:229], v[244:245], v[174:175]
    s_bitcmp1_b32 s44, 0
    s_cbranch_scc1 L_fl_35
L_bk_36:
    v_pk_fma_f32 v[176:177], v[150:151], v[158:159], v[176:177]
    v_pk_fma_f32 v[172:173], v[150:151], v[166:167], v[172:173]
    v_pk_fma_f32 v[178:179], v[230:231], v[238:239], v[178:179]
    v_pk_fma_f32 v[174:175], v[230:231], v[246:247], v[174:175]
    s_bitcmp1_b32 s44, 8
    s_cbranch_scc1 L_fl_37
L_bk_38:
    v_pk_fma_f32 v[176:177], v[152:153], v[160:161], v[176:177]
    v_pk_fma_f32 v[172:173], v[152:153], v[168:169], v[172:173]
    v_pk_fma_f32 v[178:179], v[232:233], v[240:241], v[178:179]
    v_pk_fma_f32 v[174:175], v[232:233], v[248:249], v[174:175]
    s_bitcmp1_b32 s44, 16
    s_cbranch_scc1 L_fl_39
L_bk_40:
    v_pk_fma_f32 v[176:177], v[154:155], v[162:163], v[176:177]
    v_pk_fma_f32 v[172:173], v[154:155], v[170:171], v[172:173]
    v_pk_fma_f32 v[178:179], v[234:235], v[242:243], v[178:179]
    v_pk_fma_f32 v[174:175], v[234:235], v[250:251], v[174:175]
    s_bitcmp1_b32 s44, 24
    s_cbranch_scc1 L_fl_41
L_bk_42:
    s_branch K2_MDF
K2_E1F:
    v_rcp_f32 v148, v148
    v_rcp_f32 v149, v149
    v_rcp_f32 v150, v150
    v_rcp_f32 v151, v151
    v_rcp_f32 v152, v152
    v_rcp_f32 v153, v153
    v_rcp_f32 v154, v154
    v_rcp_f32 v155, v155
    v_exp_f32 v116, v116
    v_exp_f32 v117, v117
    v_exp_f32 v118, v118
    v_exp_f32 v119, v119
    v_exp_f32 v120, v120
    v_exp_f32 v121, v121
    v_exp_f32 v122, v122
    v_exp_f32 v123, v123
    v_exp_f32 v124, v124
    v_exp_f32 v125, v125
    v_exp_f32 v126, v126
    v_exp_f32 v127, v127
    v_exp_f32 v128, v128
    v_exp_f32 v129, v129
    v_exp_f32 v130, v130
    v_exp_f32 v131, v131
    v_pk_fma_f32 v[116:117], v[116:117], s[38:39], s[38:39] clamp
    v_pk_fma_f32 v[118:119], v[118:119], s[38:39], s[38:39] clamp
    v_pk_fma_f32 v[120:121], v[120:121], s[38:39], s[38:39] clamp
    v_pk_fma_f32 v[122:123], v[122:123], s[38:39], s[38:39] clamp
    v_pk_fma_f32 v[124:125], v[124:125], s[38:39], s[38:39] clamp
    v_pk_fma_f32 v[126:127], v[126:127], s[38:39], s[38:39] clamp
    v_pk_fma_f32 v[128:129], v[128:129], s[38:39], s[38:39] clamp
    v_pk_fma_f32 v[130:131], v[130:131], s[38:39], s[38:39] clamp
    v_pk_mul_f32 v[236:237], v[118:119], v[132:133]
    v_pk_mul_f32 v[228:229], v[116:117], v[118:119]
    v_pk_add_f32 v[244:245], v[116:117], v[118:119]
    v_pk_fma_f32 v[236:237], v[116:117], v[134:135], v[236:237]
    v_pk_mul_f32 v[238:239], v[122:123], v[136:137]
    v_pk_mul_f32 v[230:231], v[120:121], v[122:123]
    v_pk_add_f32 v[246:247], v[120:121], v[122:123]
    v_pk_fma_f32 v[238:239], v[120:121], v[138:139], v[238:239]
    v_pk_mul_f32 v[240:241], v[126:127], v[140:141]
    v_pk_mul_f32 v[232:233], v[124:125], v[126:127]
    v_pk_add_f32 v[248:249], v[124:125], v[126:127]
    v_pk_fma_f32 v[240:241], v[124:125], v[142:143], v[240:241]
    v_pk_mul_f32 v[242:243], v[130:131], v[144:145]
    v_pk_mul_f32 v[234:235], v[128:129], v[130:131]
    v_pk_add_f32 v[250:251], v[128:129], v[130:131]
    v_pk_fma_f32 v[242:243], v[128:129], v[146:147], v[242:243]
    v_rcp_f32 v228, v228
    v_rcp_f32 v229, v229
    v_rcp_f32 v230, v230
    v_rcp_f32 v231, v231
    v_rcp_f32 v232, v232
    v_rcp_f32 v233, v233
    v_rcp_f32 v234, v234
    v_rcp_f32 v235, v235
    s_nop 0
    v_pk_fma_f32 v[176:177], v[148:149], v[156:157], v[176:177]
    v_pk_fma_f32 v[172:173], v[148:149], v[164:165], v[172:173]
    v_pk_fma_f32 v[178:179], v[228:229], v[236:237], v[178:179]
    v_pk_fma_f32 v[174:175], v[228:229], v[244:245], v[174:175]
    s_bitcmp1_b32 s45, 0
    s_cbranch_scc1 L_fl_43
L_bk_44:
    v_pk_fma_f32 v[176:177], v[150:151], v[158:159], v[176:177]
    v_pk_fma_f32 v[172:173], v[150:151], v[166:167], v[172:173]
    v_pk_fma_f32 v[178:179], v[230:231], v[238:239], v[178:179]
    v_pk_fma_f32 v[174:175], v[230:231], v[246:247], v[174:175]
    s_bitcmp1_b32 s45, 8
    s_cbranch_scc1 L_fl_45
L_bk_46:
    v_pk_fma_f32 v[176:177], v[152:153], v[160:161], v[176:177]
    v_pk_fma_f32 v[172:173], v[152:153], v[168:169], v[172:173]
    v_pk_fma_f32 v[178:179], v[232:233], v[240:241], v[178:179]
    v_pk_fma_f32 v[174:175], v[232:233], v[248:249], v[174:175]
    s_bitcmp1_b32 s45, 16
    s_cbranch_scc1 L_fl_47
L_bk_48:
    v_pk_fma_f32 v[176:177], v[154:155], v[162:163], v[176:177]
    v_pk_fma_f32 v[172:173], v[154:155], v[170:171], v[172:173]
    v_pk_fma_f32 v[178:179], v[234:235], v[242:243], v[178:179]
    v_pk_fma_f32 v[174:175], v[234:235], v[250:251], v[174:175]
    s_bitcmp1_b32 s45, 24
    s_cbranch_scc1 L_fl_49
L_bk_50:
    s_branch K2_MDF
K2_SWPF:
    s_cmp_ge_u32 s28, 4
    s_cbranch_scc1 K2_SW0F
    s_setprio 1
    s_branch K2_SWBF
K2_SW0F:
    s_setprio 0
    s_branch K2_SWBF
L_fl_19:
    s_bfe_i32 exec_lo, s42, 0x10000
    s_bfe_i32 exec_hi, s43, 0x10000
    v_add_f32 v225, v172, v173
    v_add_f32 v226, v176, v177
    v_add_f32 v252, v174, v175
    v_add_f32 v227, v178, v179
    v_mov_b64 v[172:173], 0
    v_mov_b64 v[176:177], 0
    ds_write2_b32 v200, v225, v226 offset0:0 offset1:64
    ds_write2_b32 v200, v252, v227 offset0:32 offset1:96
    v_mov_b64 v[174:175], 0
    v_mov_b64 v[178:179], 0
    s_mov_b64 exec, -1
    s_branch L_bk_20
L_fl_21:
    s_bfe_i32 exec_lo, s42, 0x10008
    s_bfe_i32 exec_hi, s43, 0x10008
    v_add_f32 v225, v172, v173
    v_add_f32 v226, v176, v177
    v_add_f32 v252, v174, v175
    v_add_f32 v227, v178, v179
    v_mov_b64 v[172:173], 0
    v_mov_b64 v[176:177], 0
    ds_write2_b32 v201, v225, v226 offset0:0 offset1:64
    ds_write2_b32 v201, v252, v227 offset0:32 offset1:96
    v_mov_b64 v[174:175], 0
    v_mov_b64 v[178:179], 0
    s_mov_b64 exec, -1
    s_branch L_bk_22
L_fl_23:
    s_bfe_i32 exec_lo, s42, 0x10010
    s_bfe_i32 exec_hi, s43, 0x10010
    v_add_f32 v225, v172, v173
    v_add_f32 v226, v176, v177
    v_add_f32 v252, v174, v175
    v_add_f32 v227, v178, v179
    v_mov_b64 v[172:173], 0
    v_mov_b64 v[176:177], 0
    ds_write2_b32 v202, v225, v226 offset0:0 offset1:64
    ds_write2_b32 v202, v252, v227 offset0:32 offset1:96
    v_mov_b64 v[174:175], 0
    v_mov_b64 v[178:179], 0
    s_mov_b64 exec, -1
    s_branch L_bk_24
L_fl_25:
    s_bfe_i32 exec_lo, s42, 0x10018
    s_bfe_i32 exec_hi, s43, 0x10018
    v_add_f32 v225, v172, v173
    v_add_f32 v226, v176, v177
    v_add_f32 v252, v174, v175
    v_add_f32 v227, v178, v179
    v_mov_b64 v[172:173], 0
    v_mov_b64 v[176:177], 0
    ds_write2_b32 v203, v225, v226 offset0:0 offset1:64
    ds_write2_b32 v203, v252, v227 offset0:32 offset1:96
    v_mov_b64 v[174:175], 0
    v_mov_b64 v[178:179], 0
    s_mov_b64 exec, -1
    s_branch L_bk_26
L_fl_27:
    s_bfe_i32 exec_lo, s40, 0x10000
    s_bfe_i32 exec_hi, s41, 0x10000
    v_add_f32 v225, v172, v173
    v_add_f32 v226, v176, v177
    v_add_f32 v252, v174, v175
    v_add_f32 v227, v178, v179
    v_mov_b64 v[172:173], 0
    v_mov_b64 v[176:177], 0
    ds_write2_b32 v196, v225, v226 offset0:0 offset1:64
    ds_write2_b32 v196, v252, v227 offset0:32 offset1:96
    v_mov_b64 v[174:175], 0
    v_mov_b64 v[178:179], 0
    s_mov_b64 exec, -1
    s_branch L_bk_28
L_fl_29:
    s_bfe_i32 exec_lo, s40, 0x10008
    s_bfe_i32 exec_hi, s41, 0x10008
    v_add_f32 v225, v172, v173
    v_add_f32 v226, v176, v177
    v_add_f32 v252, v174, v175
    v_add_f32 v227, v178, v179
    v_mov_b64 v[172:173], 0
    v_mov_b64 v[176:177], 0
    ds_write2_b32 v197, v225, v226 offset0:0 offset1:64
    ds_write2_b32 v197, v252, v227 offset0:32 offset1:96
    v_mov_b64 v[174:175], 0
    v_mov_b64 v[178:179], 0
    s_mov_b64 exec, -1
    s_branch L_bk_30
L_fl_31:
    s_bfe_i32 exec_lo, s40, 0x10010
    s_bfe_i32 exec_hi, s41, 0x10010
    v_add_f32 v225, v172, v173
    v_add_f32 v226, v176, v177
    v_add_f32 v252, v174, v175
    v_add_f32 v227, v178, v179
    v_mov_b64 v[172:173], 0
    v_mov_b64 v[176:177], 0
    ds_write2_b32 v198, v225, v226 offset0:0 offset1:64
    ds_write2_b32 v198, v252, v227 offset0:32 offset1:96
    v_mov_b64 v[174:175], 0
    v_mov_b64 v[178:179], 0
    s_mov_b64 exec, -1
    s_branch L_bk_32
L_fl_33:
    s_bfe_i32 exec_lo, s40, 0x10018
    s_bfe_i32 exec_hi, s41, 0x10018
    v_add_f32 v225, v172, v173
    v_add_f32 v226, v176, v177
    v_add_f32 v252, v174, v175
    v_add_f32 v227, v178, v179
    v_mov_b64 v[172:173], 0
    v_mov_b64 v[176:177], 0
    ds_write2_b32 v199, v225, v226 offset0:0 offset1:64
    ds_write2_b32 v199, v252, v227 offset0:32 offset1:96
    v_mov_b64 v[174:175], 0
    v_mov_b64 v[178:179], 0
    s_mov_b64 exec, -1
    s_branch L_bk_34
L_fl_35:
    s_bfe_i32 exec_lo, s40, 0x10000
    s_bfe_i32 exec_hi, s41, 0x10000
    v_add_f32 v225, v172, v173
    v_add_f32 v226, v176, v177
    v_add_f32 v252, v174, v175
    v_add_f32 v227, v178, v179
    v_mov_b64 v[172:173], 0
    v_mov_b64 v[176:177], 0
    ds_write2_b32 v196, v225, v226 offset0:0 offset1:64
    ds_write2_b32 v196, v252, v227 offset0:32 offset1:96
    v_mov_b64 v[174:175], 0
    v_mov_b64 v[178:179], 0
    s_mov_b64 exec, -1
    s_branch L_bk_36
L_fl_37:
    s_bfe_i32 exec_lo, s40, 0x10008
    s_bfe_i32 exec_hi, s41, 0x10008
    v_add_f32 v225, v172, v173
    v_add_f32 v226, v176, v177
    v_add_f32 v252, v174, v175
    v_add_f32 v227, v178, v179
    v_mov_b64 v[172:173], 0
    v_mov_b64 v[176:177], 0
    ds_write2_b32 v197, v225, v226 offset0:0 offset1:64
    ds_write2_b32 v197, v252, v227 offset0:32 offset1:96
    v_mov_b64 v[174:175], 0
    v_mov_b64 v[178:179], 0
    s_mov_b64 exec, -1
    s_branch L_bk_38
L_fl_39:
    s_bfe_i32 exec_lo, s40, 0x10010
    s_bfe_i32 exec_hi, s41, 0x10010
    v_add_f32 v225, v172, v173
    v_add_f32 v226, v176, v177
    v_add_f32 v252, v174, v175
    v_add_f32 v227, v178, v179
    v_mov_b64 v[172:173], 0
    v_mov_b64 v[176:177], 0
    ds_write2_b32 v198, v225, v226 offset0:0 offset1:64
    ds_write2_b32 v198, v252, v227 offset0:32 offset1:96
    v_mov_b64 v[174:175], 0
    v_mov_b64 v[178:179], 0
    s_mov_b64 exec, -1
    s_branch L_bk_40
L_fl_41:
    s_bfe_i32 exec_lo, s40, 0x10018
    s_bfe_i32 exec_hi, s41, 0x10018
    v_add_f32 v225, v172, v173
    v_add_f32 v226, v176, v177
    v_add_f32 v252, v174, v175
    v_add_f32 v227, v178, v179
    v_mov_b64 v[172:173], 0
    v_mov_b64 v[176:177], 0
    ds_write2_b32 v199, v225, v226 offset0:0 offset1:64
    ds_write2_b32 v199, v252, v227 offset0:32 offset1:96
    v_mov_b64 v[174:175], 0
    v_mov_b64 v[178:179], 0
    s_mov_b64 exec, -1
    s_branch L_bk_42
L_fl_43:
    s_bfe_i32 exec_lo, s42, 0x10000
    s_bfe_i32 exec_hi, s43, 0x10000
    v_add_f32 v225, v172, v173
    v_add_f32 v226, v176, v177
    v_add_f32 v252, v174, v175
    v_add_f32 v227, v178, v179
    v_mov_b64 v[172:173], 0
    v_mov_b64 v[176:177], 0
    ds_write2_b32 v200, v225, v226 offset0:0 offset1:64
    ds_write2_b32 v200, v252, v227 offset0:32 offset1:96
    v_mov_b64 v[174:175], 0
    v_mov_b64 v[178:179], 0
    s_mov_b64 exec, -1
    s_branch L_bk_44
L_fl_45:
    s_bfe_i32 exec_lo, s42, 0x10008
    s_bfe_i32 exec_hi, s43, 0x10008
    v_add_f32 v225, v172, v173
    v_add_f32 v226, v176, v177
    v_add_f32 v252, v174, v175
    v_add_f32 v227, v178, v179
    v_mov_b64 v[172:173], 0
    v_mov_b64 v[176:177], 0
    ds_write2_b32 v201, v225, v226 offset0:0 offset1:64
    ds_write2_b32 v201, v252, v227 offset0:32 offset1:96
    v_mov_b64 v[174:175], 0
    v_mov_b64 v[178:179], 0
    s_mov_b64 exec, -1
    s_branch L_bk_46
L_fl_47:
    s_bfe_i32 exec_lo, s42, 0x10010
    s_bfe_i32 exec_hi, s43, 0x10010
    v_add_f32 v225, v172, v173
    v_add_f32 v226, v176, v177
    v_add_f32 v252, v174, v175
    v_add_f32 v227, v178, v179
    v_mov_b64 v[172:173], 0
    v_mov_b64 v[176:177], 0
    ds_write2_b32 v202, v225, v226 offset0:0 offset1:64
    ds_write2_b32 v202, v252, v227 offset0:32 offset1:96
    v_mov_b64 v[174:175], 0
    v_mov_b64 v[178:179], 0
    s_mov_b64 exec, -1
    s_branch L_bk_48
L_fl_49:
    s_bfe_i32 exec_lo, s42, 0x10018
    s_bfe_i32 exec_hi, s43, 0x10018
    v_add_f32 v225, v172, v173
    v_add_f32 v226, v176, v177
    v_add_f32 v252, v174, v175
    v_add_f32 v227, v178, v179
    v_mov_b64 v[172:173], 0
    v_mov_b64 v[176:177], 0
    ds_write2_b32 v203, v225, v226 offset0:0 offset1:64
    ds_write2_b32 v203, v252, v227 offset0:32 offset1:96
    v_mov_b64 v[174:175], 0
    v_mov_b64 v[178:179], 0
    s_mov_b64 exec, -1
    s_branch L_bk_50
K2_MDF:
    s_setprio 0
K2_EPI:
    s_mov_b32 s16, s8
    s_and_b32 s17, s9, 0xffff
    s_mov_b32 s18, 3200000
    s_mov_b32 s19, 0x20000
    s_mov_b32 s24, s4
    s_and_b32 s25, s5, 0xffff
    s_mov_b32 s26, 3200000
    s_mov_b32 s27, 0x20000
    s_mov_b32 s49, 784
    s_mov_b32 s38, 0x4e8637bd
    s_mov_b32 s39, 0x4e8637bd
    s_mov_b32 s48, 0xffff0000
    s_waitcnt vmcnt(0)
    v_and_b32 v108, 4, v0
    v_cmp_eq_u32 vcc, 0, v108
    v_mov_b32 v110, 0x03020c0c
    v_mov_b32 v109, 0x01000c0c
    v_cndmask_b32 v110, v110, v109, vcc
    v_mov_b32 v108, v0
    v_lshrrev_b32 v109, 3, v108
    v_and_b32 v108, 7, v108
    v_lshlrev_b32 v106, 5, v108
    v_mul_u32_u24 v104, s49, v109
    v_add_u32 v104, 20736, v104
    v_add_u32 v100, v104, v106
    v_and_b32 v111, 3, v108
    v_lshl_add_u32 v111, v111, 5, v104
    v_add_u32 v102, s29, v109
    v_lshlrev_b32 v102, 7, v102
    v_lshl_add_u32 v102, v108, 4, v102
    buffer_load_dwordx4 v[4:7], v102, s[24:27], 0 offen
    ds_read_b128 v[12:15], v111 offset:640
    ds_read_b128 v[16:19], v111 offset:656
    ds_read_b32 v104, v104 offset:768
    v_add_u32 v108, 512, v0
    v_lshrrev_b32 v109, 3, v108
    v_and_b32 v108, 7, v108
    v_lshlrev_b32 v107, 5, v108
    v_mul_u32_u24 v105, s49, v109
    v_add_u32 v105, 20736, v105
    v_add_u32 v101, v105, v107
    v_and_b32 v112, 3, v108
    v_lshl_add_u32 v112, v112, 5, v105
    v_add_u32 v103, s29, v109
    v_lshlrev_b32 v103, 7, v103
    v_lshl_add_u32 v103, v108, 4, v103
    v_cmp_gt_u32 s[54:55], s30, v109
    s_nop 3
    s_mov_b64 exec, s[54:55]
    s_cbranch_execz K2_NS2F
    buffer_load_dwordx4 v[8:11], v103, s[24:27], 0 offen
    ds_read_b128 v[20:23], v112 offset:640
    ds_read_b128 v[24:27], v112 offset:656
    ds_read_b32 v105, v105 offset:768
K2_NS2F:
    s_mov_b64 exec, -1
    s_waitcnt lgkmcnt(0)
    v_add_u32 v104, v104, v106
    v_add_u32 v105, v105, v107
    s_barrier
    ds_read_b128 v[28:31], v100
    ds_read_b128 v[32:35], v100 offset:16
    ds_read_b128 v[36:39], v100 offset:256
    ds_read_b128 v[40:43], v100 offset:272
    ds_read_b128 v[44:47], v104
    ds_read_b128 v[48:51], v104 offset:16
    ds_read_b128 v[52:55], v104 offset:256
    ds_read_b128 v[56:59], v104 offset:272
    s_mov_b64 exec, s[54:55]
    s_cbranch_execz K2_ONEF
    ds_read_b128 v[60:63], v101
    ds_read_b128 v[64:67], v101 offset:16
    ds_read_b128 v[68:71], v101 offset:256
    ds_read_b128 v[72:75], v101 offset:272
    ds_read_b128 v[76:79], v105
    ds_read_b128 v[80:83], v105 offset:16
    ds_read_b128 v[84:87], v105 offset:256
    s_waitcnt lgkmcnt(14)
    ds_read_b128 v[88:91], v105 offset:272
    s_mov_b64 exec, -1
    s_waitcnt vmcnt(0) lgkmcnt(8)
    v_pk_add_f32 v[28:29], v[28:29], v[44:45]
    v_pk_add_f32 v[36:37], v[36:37], v[52:53]
    v_pk_add_f32 v[30:31], v[30:31], v[46:47]
    v_pk_add_f32 v[38:39], v[38:39], v[54:55]
    v_pk_add_f32 v[32:33], v[32:33], v[48:49]
    v_pk_add_f32 v[40:41], v[40:41], v[56:57]
    v_pk_add_f32 v[34:35], v[34:35], v[50:51]
    v_pk_add_f32 v[42:43], v[42:43], v[58:59]
    v_pk_add_f32 v[28:29], v[28:29], s[38:39]
    v_pk_add_f32 v[30:31], v[30:31], s[38:39]
    v_pk_add_f32 v[32:33], v[32:33], s[38:39]
    v_pk_add_f32 v[34:35], v[34:35], s[38:39]
    v_rcp_f32 v28, v28
    v_rcp_f32 v29, v29
    v_rcp_f32 v30, v30
    v_rcp_f32 v31, v31
    v_rcp_f32 v32, v32
    v_rcp_f32 v33, v33
    v_rcp_f32 v34, v34
    v_rcp_f32 v35, v35
    v_perm_b32 v44, v12, v12, v110
    v_perm_b32 v45, v13, v13, v110
    v_perm_b32 v46, v14, v14, v110
    v_perm_b32 v47, v15, v15, v110
    v_perm_b32 v48, v16, v16, v110
    v_perm_b32 v49, v17, v17, v110
    v_perm_b32 v50, v18, v18, v110
    v_perm_b32 v51, v19, v19, v110
    v_pk_fma_f32 v[36:37], v[36:37], v[28:29], v[44:45]
    v_pk_fma_f32 v[38:39], v[38:39], v[30:31], v[46:47]
    v_pk_fma_f32 v[40:41], v[40:41], v[32:33], v[48:49]
    v_pk_fma_f32 v[42:43], v[42:43], v[34:35], v[50:51]
    v_max_f32 v36, 0, v36
    v_max_f32 v37, 0, v37
    v_max_f32 v38, 0, v38
    v_max_f32 v39, 0, v39
    v_max_f32 v40, 0, v40
    v_max_f32 v41, 0, v41
    v_max_f32 v42, 0, v42
    v_max_f32 v43, 0, v43
    v_lshlrev_b32 v44, 16, v4
    v_and_b32 v45, s48, v4
    v_lshlrev_b32 v46, 16, v5
    v_and_b32 v47, s48, v5
    v_lshlrev_b32 v48, 16, v6
    v_and_b32 v49, s48, v6
    v_lshlrev_b32 v50, 16, v7
    v_and_b32 v51, s48, v7
    v_pk_add_f32 v[36:37], v[36:37], v[44:45]
    v_pk_add_f32 v[38:39], v[38:39], v[46:47]
    v_pk_add_f32 v[40:41], v[40:41], v[48:49]
    v_pk_add_f32 v[42:43], v[42:43], v[50:51]
    v_cvt_pk_bf16_f32 v92, v36, v37
    v_cvt_pk_bf16_f32 v93, v38, v39
    v_cvt_pk_bf16_f32 v94, v40, v41
    v_cvt_pk_bf16_f32 v95, v42, v43
    buffer_store_dwordx4 v[92:95], v102, s[16:19], 0 offen sc1
    s_mov_b64 exec, s[54:55]
    s_waitcnt lgkmcnt(0)
    v_pk_add_f32 v[60:61], v[60:61], v[76:77]
    v_pk_add_f32 v[68:69], v[68:69], v[84:85]
    v_pk_add_f32 v[62:63], v[62:63], v[78:79]
    v_pk_add_f32 v[70:71], v[70:71], v[86:87]
    v_pk_add_f32 v[64:65], v[64:65], v[80:81]
    v_pk_add_f32 v[72:73], v[72:73], v[88:89]
    v_pk_add_f32 v[66:67], v[66:67], v[82:83]
    v_pk_add_f32 v[74:75], v[74:75], v[90:91]
    v_pk_add_f32 v[60:61], v[60:61], s[38:39]
    v_pk_add_f32 v[62:63], v[62:63], s[38:39]
    v_pk_add_f32 v[64:65], v[64:65], s[38:39]
    v_pk_add_f32 v[66:67], v[66:67], s[38:39]
    v_rcp_f32 v60, v60
    v_rcp_f32 v61, v61
    v_rcp_f32 v62, v62
    v_rcp_f32 v63, v63
    v_rcp_f32 v64, v64
    v_rcp_f32 v65, v65
    v_rcp_f32 v66, v66
    v_rcp_f32 v67, v67
    v_perm_b32 v76, v20, v20, v110
    v_perm_b32 v77, v21, v21, v110
    v_perm_b32 v78, v22, v22, v110
    v_perm_b32 v79, v23, v23, v110
    v_perm_b32 v80, v24, v24, v110
    v_perm_b32 v81, v25, v25, v110
    v_perm_b32 v82, v26, v26, v110
    v_perm_b32 v83, v27, v27, v110
    v_pk_fma_f32 v[68:69], v[68:69], v[60:61], v[76:77]
    v_pk_fma_f32 v[70:71], v[70:71], v[62:63], v[78:79]
    v_pk_fma_f32 v[72:73], v[72:73], v[64:65], v[80:81]
    v_pk_fma_f32 v[74:75], v[74:75], v[66:67], v[82:83]
    v_max_f32 v68, 0, v68
    v_max_f32 v69, 0, v69
    v_max_f32 v70, 0, v70
    v_max_f32 v71, 0, v71
    v_max_f32 v72, 0, v72
    v_max_f32 v73, 0, v73
    v_max_f32 v74, 0, v74
    v_max_f32 v75, 0, v75
    v_lshlrev_b32 v76, 16, v8
    v_and_b32 v77, s48, v8
    v_lshlrev_b32 v78, 16, v9
    v_and_b32 v79, s48, v9
    v_lshlrev_b32 v80, 16, v10
    v_and_b32 v81, s48, v10
    v_lshlrev_b32 v82, 16, v11
    v_and_b32 v83, s48, v11
    v_pk_add_f32 v[68:69], v[68:69], v[76:77]
    v_pk_add_f32 v[70:71], v[70:71], v[78:79]
    v_pk_add_f32 v[72:73], v[72:73], v[80:81]
    v_pk_add_f32 v[74:75], v[74:75], v[82:83]
    v_cvt_pk_bf16_f32 v96, v68, v69
    v_cvt_pk_bf16_f32 v97, v70, v71
    v_cvt_pk_bf16_f32 v98, v72, v73
    v_cvt_pk_bf16_f32 v99, v74, v75
    buffer_store_dwordx4 v[96:99], v103, s[16:19], 0 offen sc1
    s_branch K2_FINF
K2_ONEF:
    s_mov_b64 exec, -1
    s_waitcnt vmcnt(0) lgkmcnt(0)
    v_pk_add_f32 v[28:29], v[28:29], v[44:45]
    v_pk_add_f32 v[36:37], v[36:37], v[52:53]
    v_pk_add_f32 v[30:31], v[30:31], v[46:47]
    v_pk_add_f32 v[38:39], v[38:39], v[54:55]
    v_pk_add_f32 v[32:33], v[32:33], v[48:49]
    v_pk_add_f32 v[40:41], v[40:41], v[56:57]
    v_pk_add_f32 v[34:35], v[34:35], v[50:51]
    v_pk_add_f32 v[42:43], v[42:43], v[58:59]
    v_pk_add_f32 v[28:29], v[28:29], s[38:39]
    v_pk_add_f32 v[30:31], v[30:31], s[38:39]
    v_pk_add_f32 v[32:33], v[32:33], s[38:39]
    v_pk_add_f32 v[34:35], v[34:35], s[38:39]
    v_rcp_f32 v28, v28
    v_rcp_f32 v29, v29
    v_rcp_f32 v30, v30
    v_rcp_f32 v31, v31
    v_rcp_f32 v32, v32
    v_rcp_f32 v33, v33
    v_rcp_f32 v34, v34
    v_rcp_f32 v35, v35
    v_perm_b32 v44, v12, v12, v110
    v_perm_b32 v45, v13, v13, v110
    v_perm_b32 v46, v14, v14, v110
    v_perm_b32 v47, v15, v15, v110
    v_perm_b32 v48, v16, v16, v110
    v_perm_b32 v49, v17, v17, v110
    v_perm_b32 v50, v18, v18, v110
    v_perm_b32 v51, v19, v19, v110
    v_pk_fma_f32 v[36:37], v[36:37], v[28:29], v[44:45]
    v_pk_fma_f32 v[38:39], v[38:39], v[30:31], v[46:47]
    v_pk_fma_f32 v[40:41], v[40:41], v[32:33], v[48:49]
    v_pk_fma_f32 v[42:43], v[42:43], v[34:35], v[50:51]
    v_max_f32 v36, 0, v36
    v_max_f32 v37, 0, v37
    v_max_f32 v38, 0, v38
    v_max_f32 v39, 0, v39
    v_max_f32 v40, 0, v40
    v_max_f32 v41, 0, v41
    v_max_f32 v42, 0, v42
    v_max_f32 v43, 0, v43
    v_lshlrev_b32 v44, 16, v4
    v_and_b32 v45, s48, v4
    v_lshlrev_b32 v46, 16, v5
    v_and_b32 v47, s48, v5
    v_lshlrev_b32 v48, 16, v6
    v_and_b32 v49, s48, v6
    v_lshlrev_b32 v50, 16, v7
    v_and_b32 v51, s48, v7
    v_pk_add_f32 v[36:37], v[36:37], v[44:45]
    v_pk_add_f32 v[38:39], v[38:39], v[46:47]
    v_pk_add_f32 v[40:41], v[40:41], v[48:49]
    v_pk_add_f32 v[42:43], v[42:43], v[50:51]
    v_cvt_pk_bf16_f32 v92, v36, v37
    v_cvt_pk_bf16_f32 v93, v38, v39
    v_cvt_pk_bf16_f32 v94, v40, v41
    v_cvt_pk_bf16_f32 v95, v42, v43
    buffer_store_dwordx4 v[92:95], v102, s[16:19], 0 offen sc1
K2_FINF:
    s_waitcnt vmcnt(0)
    s_endpgm
K2_CSEL:
    v_mov_b32 v230, 0
    v_mov_b32 v231, 0
    v_mov_b32 v232, 0
    v_lshrrev_b32 v233, 24, v132
    v_cmp_lt_u32 vcc, 32, v233
    v_mad_u32_u24 v251, v132, 8, v228
    v_add_u32 v225, 1, v232
    v_cndmask_b32 v230, v230, v251, vcc
    v_cndmask_b32 v231, v231, v233, vcc
    v_cndmask_b32 v232, v232, v225, vcc
    v_lshrrev_b32 v233, 24, v133
    v_cmp_lt_u32 vcc, 32, v233
    v_mad_u32_u24 v251, v133, 8, v228
    v_add_u32 v225, 1, v232
    v_cndmask_b32 v230, v230, v251, vcc
    v_cndmask_b32 v231, v231, v233, vcc
    v_cndmask_b32 v232, v232, v225, vcc
    v_lshrrev_b32 v233, 24, v134
    v_cmp_lt_u32 vcc, 32, v233
    v_mad_u32_u24 v251, v134, 8, v228
    v_add_u32 v225, 1, v232
    v_cndmask_b32 v230, v230, v251, vcc
    v_cndmask_b32 v231, v231, v233, vcc
    v_cndmask_b32 v232, v232, v225, vcc
    v_lshrrev_b32 v233, 24, v135
    v_cmp_lt_u32 vcc, 32, v233
    v_mad_u32_u24 v251, v135, 8, v228
    v_add_u32 v225, 1, v232
    v_cndmask_b32 v230, v230, v251, vcc
    v_cndmask_b32 v231, v231, v233, vcc
    v_cndmask_b32 v232, v232, v225, vcc
    v_cmp_lt_u32 vcc, 1, v232
    v_cmp_lt_u32 s[56:57], 48, v231
    v_add_u32 v233, 32, v229
    s_or_b64 s[56:57], s[56:57], vcc
    v_cmp_gt_u32 s[92:93], v231, v233
    v_add_u32 v233, 33, v229
    v_cmp_gt_u32 s[94:95], v231, v233
    s_nop 0
    s_mov_b64 exec, s[92:93]
    buffer_load_dwordx4 v[252:255], v230, s[20:23], 0 offen offset:256
    s_mov_b64 exec, -1
    s_branch K2_CBACK
K2_ZROWS:
    s_mov_b64 exec, s[54:55]
    v_mov_b32 v240, 0
    v_mov_b32 v241, 0
    v_mov_b32 v242, 0
    v_mov_b32 v243, 0
    v_cmp_eq_u32 vcc, 0, v236
    s_and_b64 exec, vcc, s[54:55]
    ds_write_b128 v200, v[240:243] offset:0
    ds_write_b128 v200, v[240:243] offset:16
    ds_write_b128 v200, v[240:243] offset:32
    ds_write_b128 v200, v[240:243] offset:48
    ds_write_b128 v200, v[240:243] offset:64
    ds_write_b128 v200, v[240:243] offset:80
    ds_write_b128 v200, v[240:243] offset:96
    ds_write_b128 v200, v[240:243] offset:112
    ds_write_b128 v200, v[240:243] offset:128
    ds_write_b128 v200, v[240:243] offset:144
    ds_write_b128 v200, v[240:243] offset:160
    ds_write_b128 v200, v[240:243] offset:176
    ds_write_b128 v200, v[240:243] offset:192
    ds_write_b128 v200, v[240:243] offset:208
    ds_write_b128 v200, v[240:243] offset:224
    ds_write_b128 v200, v[240:243] offset:240
    ds_write_b128 v200, v[240:243] offset:256
    ds_write_b128 v200, v[240:243] offset:272
    ds_write_b128 v200, v[240:243] offset:288
    ds_write_b128 v200, v[240:243] offset:304
    ds_write_b128 v200, v[240:243] offset:320
    ds_write_b128 v200, v[240:243] offset:336
    ds_write_b128 v200, v[240:243] offset:352
    ds_write_b128 v200, v[240:243] offset:368
    ds_write_b128 v200, v[240:243] offset:384
    ds_write_b128 v200, v[240:243] offset:400
    ds_write_b128 v200, v[240:243] offset:416
    ds_write_b128 v200, v[240:243] offset:432
    ds_write_b128 v200, v[240:243] offset:448
    ds_write_b128 v200, v[240:243] offset:464
    ds_write_b128 v200, v[240:243] offset:480
    ds_write_b128 v200, v[240:243] offset:496
    s_mov_b64 exec, s[54:55]
    v_cmp_eq_u32 vcc, 0, v237
    s_and_b64 exec, vcc, s[54:55]
    ds_write_b128 v200, v[240:243] offset:784
    ds_write_b128 v200, v[240:243] offset:800
    ds_write_b128 v200, v[240:243] offset:816
    ds_write_b128 v200, v[240:243] offset:832
    ds_write_b128 v200, v[240:243] offset:848
    ds_write_b128 v200, v[240:243] offset:864
    ds_write_b128 v200, v[240:243] offset:880
    ds_write_b128 v200, v[240:243] offset:896
    ds_write_b128 v200, v[240:243] offset:912
    ds_write_b128 v200, v[240:243] offset:928
    ds_write_b128 v200, v[240:243] offset:944
    ds_write_b128 v200, v[240:243] offset:960
    ds_write_b128 v200, v[240:243] offset:976
    ds_write_b128 v200, v[240:243] offset:992
    ds_write_b128 v200, v[240:243] offset:1008
    ds_write_b128 v200, v[240:243] offset:1024
    ds_write_b128 v200, v[240:243] offset:1040
    ds_write_b128 v200, v[240:243] offset:1056
    ds_write_b128 v200, v[240:243] offset:1072
    ds_write_b128 v200, v[240:243] offset:1088
    ds_write_b128 v200, v[240:243] offset:1104
    ds_write_b128 v200, v[240:243] offset:1120
    ds_write_b128 v200, v[240:243] offset:1136
    ds_write_b128 v200, v[240:243] offset:1152
    ds_write_b128 v200, v[240:243] offset:1168
    ds_write_b128 v200, v[240:243] offset:1184
    ds_write_b128 v200, v[240:243] offset:1200
    ds_write_b128 v200, v[240:243] offset:1216
    ds_write_b128 v200, v[240:243] offset:1232
    ds_write_b128 v200, v[240:243] offset:1248
    ds_write_b128 v200, v[240:243] offset:1264
    ds_write_b128 v200, v[240:243] offset:1280
    s_mov_b64 exec, s[54:55]
    s_mov_b64 exec, -1
    s_branch K2_ZBACK
K2_SLOW:
    v_lshlrev_b32 v249, 4, v1
    v_add_u32 v249, 108032, v249
    ds_read_b128 v[4:7], v249 offset:0
    ds_read_b128 v[8:11], v249 offset:1024
    ds_read_b128 v[12:15], v249 offset:2048
    ds_read_b128 v[16:19], v249 offset:3072
    ds_read_b128 v[20:23], v249 offset:4096
    ds_read_b128 v[24:27], v249 offset:5120
    ds_read_b128 v[28:31], v249 offset:6144
    ds_read_b128 v[32:35], v249 offset:7168
    ds_read_b128 v[36:39], v249 offset:8192
    ds_read_b128 v[40:43], v249 offset:9216
    ds_read_b128 v[44:47], v249 offset:10240
    ds_read_b128 v[48:51], v249 offset:11264
    s_waitcnt lgkmcnt(8)
    ds_read_b128 v[52:55], v249 offset:12288
    ds_read_b128 v[56:59], v249 offset:13312
    ds_read_b128 v[60:63], v249 offset:14336
    ds_read_b128 v[64:67], v249 offset:15360
    v_add_u32 v208, s58, v208
    v_xor_b32 v209, 32, v208
    v_xor_b32 v210, 64, v208
    v_xor_b32 v211, 96, v208
    s_mov_b32 s53, 0xbfb8aa3b
    v_lshlrev_b32 v2, 16, v2
    v_mul_f32 v2, s53, v2
    v_lshlrev_b32 v3, 16, v3
    v_mul_f32 v3, s53, v3
    v_cvt_pk_bf16_f32 v2, 0, v2
    v_cvt_pk_bf16_f32 v3, v3, 0
    v_cmp_gt_u32 vcc, 32, v1
    v_mov_b32 v233, 0xb2000000
    v_mov_b32 v234, 0xb200
    v_cndmask_b32 v2, v233, v2, vcc
    v_cndmask_b32 v3, v234, v3, vcc
    s_waitcnt vmcnt(0) lgkmcnt(0)
    s_barrier
    v_lshlrev_b32 v228, 2, v1
    s_lshl_b32 s50, s2, 2
    s_add_u32 s50, s50, 7340032
    s_add_u32 s16, s10, s50
    s_addc_u32 s17, s11, 0
    s_and_b32 s17, s17, 0xffff
    s_mov_b32 s18, 262208
    s_mov_b32 s19, 0x20000
    v_lshlrev_b32 v233, 10, v228
    buffer_load_dword v132, v233, s[16:19], 0 offen offset:0
    buffer_load_dword v133, v233, s[16:19], 0 offen offset:1024
    buffer_load_dword v134, v233, s[16:19], 0 offen offset:2048
    buffer_load_dword v135, v233, s[16:19], 0 offen offset:3072
    v_add_u32 v233, 4, v233
    buffer_load_dword v236, v233, s[16:19], 0 offen offset:0
    buffer_load_dword v237, v233, s[16:19], 0 offen offset:1024
    buffer_load_dword v238, v233, s[16:19], 0 offen offset:2048
    buffer_load_dword v239, v233, s[16:19], 0 offen offset:3072
    s_mov_b32 s49, 0xfffff
    s_cmp_eq_u32 s2, 255
    s_cselect_b64 s[54:55], -1, 0
    s_waitcnt vmcnt(0)
    v_add_u32 v233, 1, v228
    v_mul_u32_u24 v233, 3136, v233
    v_min_u32 v233, 800000, v233
    v_and_b32 v236, s49, v236
    v_cndmask_b32 v236, v236, v233, s[54:55]
    v_and_b32 v233, s49, v132
    v_sub_u32 v236, v236, v233
    v_add_u32 v233, 2, v228
    v_mul_u32_u24 v233, 3136, v233
    v_min_u32 v233, 800000, v233
    v_and_b32 v237, s49, v237
    v_cndmask_b32 v237, v237, v233, s[54:55]
    v_and_b32 v233, s49, v133
    v_sub_u32 v237, v237, v233
    v_add_u32 v233, 3, v228
    v_mul_u32_u24 v233, 3136, v233
    v_min_u32 v233, 800000, v233
    v_and_b32 v238, s49, v238
    v_cndmask_b32 v238, v238, v233, s[54:55]
    v_and_b32 v233, s49, v134
    v_sub_u32 v238, v238, v233
    v_add_u32 v233, 4, v228
    v_mul_u32_u24 v233, 3136, v233
    v_min_u32 v233, 800000, v233
    v_and_b32 v239, s49, v239
    v_cndmask_b32 v239, v239, v233, s[54:55]
    v_and_b32 v233, s49, v135
    v_sub_u32 v239, v239, v233
    v_max_u32 v231, v236, v237
    v_max3_u32 v231, v231, v238, v239
    s_nop 1
    v_max_u32_dpp v231, v231, v231 row_shr:1 row_mask:0xf bank_mask:0xf
    s_nop 1
    v_max_u32_dpp v231, v231, v231 row_shr:2 row_mask:0xf bank_mask:0xf
    s_nop 1
    v_max_u32_dpp v231, v231, v231 row_shr:4 row_mask:0xf bank_mask:0xf
    s_nop 1
    v_max_u32_dpp v231, v231, v231 row_shr:8 row_mask:0xf bank_mask:0xf
    s_nop 1
    v_max_u32_dpp v231, v231, v231 row_bcast:15 row_mask:0xa bank_mask:0xf
    s_nop 1
    v_max_u32_dpp v231, v231, v231 row_bcast:31 row_mask:0xc bank_mask:0xf
    s_nop 0
    v_readlane_b32 s50, v231, 63
    s_add_u32 s50, s50, 12
    s_mul_i32 s50, s50, 5042
    s_lshr_b32 s32, s50, 16
    s_mov_b32 s31, 0
    v_mov_b32 v240, 0
    v_mov_b32 v241, 0
    v_mov_b32 v242, 0
    v_mov_b32 v243, 0
    v_lshrrev_b32 v227, 5, v0
    v_mul_u32_u24 v227, 784, v227
    v_and_b32 v228, 31, v1
    v_lshl_add_u32 v227, v228, 4, v227
    v_add_u32 v227, 20736, v227
    ds_write_b128 v227, v[240:243]
    v_add_u32 v227, 12544, v227
    ds_write_b128 v227, v[240:243]
    v_add_u32 v227, 12544, v227
    ds_write_b128 v227, v[240:243]
    v_add_u32 v227, 12544, v227
    ds_write_b128 v227, v[240:243]
    v_add_u32 v227, 12544, v227
    ds_write_b128 v227, v[240:243]
    v_add_u32 v227, 12544, v227
    ds_write_b128 v227, v[240:243]
    v_add_u32 v227, 12544, v227
    v_cmp_gt_u32 vcc, 64, v0
    s_and_saveexec_b64 s[54:55], vcc
    ds_write_b128 v227, v[240:243]
    s_mov_b64 exec, s[54:55]
K2_SPASS:
    s_lshl_b32 s49, s28, 1
    v_lshrrev_b32 v244, 5, v1
    v_add_u32 v244, s49, v244
    v_bfe_u32 v245, v1, 3, 2
    v_bfe_u32 v246, v1, 2, 1
    v_add_u32 v246, s49, v246
    v_and_b32 v247, 3, v1
    v_lshlrev_b32 v247, 2, v247
    v_lshrrev_b32 v227, 3, v1
    v_lshlrev_b32 v227, 2, v227
    s_lshl_b32 s49, s28, 5
    v_add_u32 v227, s49, v227
    s_lshl_b32 s50, s2, 2
    s_add_u32 s50, s50, 7340032
    s_add_u32 s16, s10, s50
    s_addc_u32 s17, s11, 0
    s_and_b32 s17, s17, 0xffff
    s_mov_b32 s18, 262208
    s_mov_b32 s19, 0x20000
    v_lshlrev_b32 v233, 10, v227
    buffer_load_dword v132, v233, s[16:19], 0 offen offset:0
    buffer_load_dword v133, v233, s[16:19], 0 offen offset:1024
    buffer_load_dword v134, v233, s[16:19], 0 offen offset:2048
    buffer_load_dword v135, v233, s[16:19], 0 offen offset:3072
    v_add_u32 v233, 4, v233
    buffer_load_dword v236, v233, s[16:19], 0 offen offset:0
    buffer_load_dword v237, v233, s[16:19], 0 offen offset:1024
    buffer_load_dword v238, v233, s[16:19], 0 offen offset:2048
    buffer_load_dword v239, v233, s[16:19], 0 offen offset:3072
    s_mov_b32 s49, 0xfffff
    s_cmp_eq_u32 s2, 255
    s_cselect_b64 s[54:55], -1, 0
    s_waitcnt vmcnt(0)
    v_add_u32 v233, 1, v227
    v_mul_u32_u24 v233, 3136, v233
    v_min_u32 v233, 800000, v233
    v_and_b32 v236, s49, v236
    v_cndmask_b32 v236, v236, v233, s[54:55]
    v_and_b32 v233, s49, v132
    v_sub_u32 v236, v236, v233
    v_add_u32 v233, 2, v227
    v_mul_u32_u24 v233, 3136, v233
    v_min_u32 v233, 800000, v233
    v_and_b32 v237, s49, v237
    v_cndmask_b32 v237, v237, v233, s[54:55]
    v_and_b32 v233, s49, v133
    v_sub_u32 v237, v237, v233
    v_add_u32 v233, 3, v227
    v_mul_u32_u24 v233, 3136, v233
    v_min_u32 v233, 800000, v233
    v_and_b32 v238, s49, v238
    v_cndmask_b32 v238, v238, v233, s[54:55]
    v_and_b32 v233, s49, v134
    v_sub_u32 v238, v238, v233
    v_add_u32 v233, 4, v227
    v_mul_u32_u24 v233, 3136, v233
    v_min_u32 v233, 800000, v233
    v_and_b32 v239, s49, v239
    v_cndmask_b32 v239, v239, v233, s[54:55]
    v_and_b32 v233, s49, v135
    v_sub_u32 v239, v239, v233
    v_mov_b32 v68, v236
    v_mov_b32 v69, v237
    v_mov_b32 v70, v238
    v_mov_b32 v71, v239
    v_and_b32 v229, 7, v1
    v_lshlrev_b32 v229, 1, v229
    s_mul_i32 s49, s31, 13
    v_add_u32 v228, s49, v229
    v_lshlrev_b32 v228, 3, v228
    v_mov_b32 v232, 0x10000
    s_mov_b64 s[92:93], 0
    s_mov_b64 s[94:95], 0
    v_add_u32 v230, 0, v229
    v_cmp_gt_u32 vcc, 13, v230
    v_add_u32 v230, s49, v230
    s_nop 0
    v_cndmask_b32 v231, v232, v230, vcc
    v_add_u32 v230, 1, v229
    v_cmp_gt_u32 vcc, 13, v230
    v_add_u32 v230, s49, v230
    s_nop 0
    v_cndmask_b32 v233, v232, v230, vcc
    v_cmp_gt_u32 s[60:61], v68, v231
    v_cmp_gt_u32 s[62:63], v68, v233
    v_cmp_gt_u32 s[64:65], v69, v231
    v_cmp_gt_u32 s[66:67], v69, v233
    v_cmp_gt_u32 s[68:69], v70, v231
    v_cmp_gt_u32 s[70:71], v70, v233
    v_cmp_gt_u32 s[72:73], v71, v231
    v_cmp_gt_u32 s[74:75], v71, v233
    s_mov_b64 s[76:77], 0
    s_mov_b64 s[78:79], 0
    s_mov_b64 s[80:81], 0
    s_mov_b64 s[82:83], 0
    s_mov_b64 s[84:85], 0
    s_mov_b64 s[86:87], 0
    s_mov_b64 s[88:89], 0
    s_mov_b64 s[90:91], 0
    v_mad_u32_u24 v116, v132, 8, v228
    v_mad_u32_u24 v117, v133, 8, v228
    v_mad_u32_u24 v118, v134, 8, v228
    v_mad_u32_u24 v119, v135, 8, v228
    s_mov_b64 exec, s[60:61]
    buffer_load_dwordx4 v[148:151], v116, s[20:23], 0 offen
    s_mov_b64 exec, s[64:65]
    buffer_load_dwordx4 v[152:155], v117, s[20:23], 0 offen
    s_mov_b64 exec, s[68:69]
    buffer_load_dwordx4 v[156:159], v118, s[20:23], 0 offen
    s_mov_b64 exec, s[72:73]
    buffer_load_dwordx4 v[160:163], v119, s[20:23], 0 offen
    s_mov_b64 exec, -1
    v_lshlrev_b32 v231, 4, v0
    v_mov_b32 v240, 0xffff
    v_mov_b32 v241, 0xffff
    v_mov_b64 v[242:243], v[240:241]
    ds_write_b128 v231, v[240:243] offset:5376
    s_cmp_ge_u32 s28, 7
    s_cbranch_scc1 K2_I11
    ds_write_b128 v231, v[240:243] offset:13568
K2_I11:
    v_mov_b32 v240, 97568
    v_mov_b32 v241, 97568
    v_mov_b64 v[242:243], v[240:241]
    v_cmp_gt_u32 vcc, 240, v0
    s_and_saveexec_b64 s[54:55], vcc
    ds_write_b128 v231, v[240:243] offset:1536
    s_mov_b64 exec, s[54:55]
    s_cmp_lg_u32 s28, 0
    s_cbranch_scc1 K2_I21
    v_mov_b64 v[240:241], 0
    v_mov_b64 v[242:243], 0
    ds_write_b128 v231, v[240:243] offset:0
    v_add_u32 v231, 98080, v231
    s_mov_b64 exec, 0xff
    ds_write_b128 v231, v[240:243]
    s_mov_b64 exec, -1
K2_I21:
    s_waitcnt vmcnt(0) lgkmcnt(0)
    s_barrier
    v_mov_b32 v231, 1
    s_mov_b64 exec, s[60:61]
    ds_add_rtn_u32 v116, v149, v231 offset:0
    s_mov_b64 exec, s[62:63]
    ds_add_rtn_u32 v117, v151, v231 offset:0
    s_mov_b64 exec, s[64:65]
    ds_add_rtn_u32 v118, v153, v231 offset:0
    s_mov_b64 exec, s[66:67]
    ds_add_rtn_u32 v119, v155, v231 offset:0
    s_mov_b64 exec, s[68:69]
    ds_add_rtn_u32 v120, v157, v231 offset:0
    s_mov_b64 exec, s[70:71]
    ds_add_rtn_u32 v121, v159, v231 offset:0
    s_mov_b64 exec, s[72:73]
    ds_add_rtn_u32 v122, v161, v231 offset:0
    s_mov_b64 exec, s[74:75]
    ds_add_rtn_u32 v123, v163, v231 offset:0
    s_waitcnt lgkmcnt(6)
    s_mov_b64 exec, s[76:77]
    s_cbranch_execz L_skh_51
    ds_add_rtn_u32 v124, v165, v231 offset:0
    s_mov_b64 exec, s[78:79]
    ds_add_rtn_u32 v125, v167, v231 offset:0
L_skh_51:
    s_mov_b64 exec, s[80:81]
    s_cbranch_execz L_skh_52
    ds_add_rtn_u32 v126, v169, v231 offset:0
    s_mov_b64 exec, s[82:83]
    ds_add_rtn_u32 v127, v171, v231 offset:0
L_skh_52:
    s_mov_b64 exec, s[84:85]
    s_cbranch_execz L_skh_53
    ds_add_rtn_u32 v128, v173, v231 offset:0
    s_mov_b64 exec, s[86:87]
    ds_add_rtn_u32 v129, v175, v231 offset:0
L_skh_53:
    s_mov_b64 exec, s[88:89]
    s_cbranch_execz L_skh_54
    ds_add_rtn_u32 v130, v177, v231 offset:0
    s_mov_b64 exec, s[90:91]
    ds_add_rtn_u32 v131, v179, v231 offset:0
L_skh_54:
    s_mov_b64 exec, s[92:93]
    s_cbranch_execz L_skhc_55
    s_waitcnt lgkmcnt(6)
    ds_add_rtn_u32 v225, v253, v231 offset:0
    s_mov_b64 exec, s[94:95]
    ds_add_rtn_u32 v226, v255, v231 offset:0
L_skhc_55:
    s_mov_b64 exec, -1
    s_waitcnt lgkmcnt(0)
    s_barrier
    v_lshlrev_b32 v227, 3, v1
    ds_read_b64 v[236:237], v227 offset:0
    v_mul_u32_u24 v200, 1568, v1
    v_add_u32 v200, 20736, v200
    s_waitcnt lgkmcnt(0)
    v_add_u32 v231, 3, v236
    v_add_u32 v232, 3, v237
    v_and_b32 v231, -4, v231
    v_and_b32 v232, -4, v232
    v_add_u32 v229, v231, v232
    v_max_u32 v228, v231, v232
    v_mov_b32 v230, v229
    s_nop 1
    v_add_u32_dpp v230, v230, v230 row_shr:1 row_mask:0xf bank_mask:0xf
    s_nop 1
    v_add_u32_dpp v230, v230, v230 row_shr:2 row_mask:0xf bank_mask:0xf
    s_nop 1
    v_add_u32_dpp v230, v230, v230 row_shr:4 row_mask:0xf bank_mask:0xf
    s_nop 1
    v_add_u32_dpp v230, v230, v230 row_shr:8 row_mask:0xf bank_mask:0xf
    s_nop 1
    v_add_u32_dpp v230, v230, v230 row_bcast:15 row_mask:0xa bank_mask:0xf
    s_nop 1
    v_add_u32_dpp v230, v230, v230 row_bcast:31 row_mask:0xc bank_mask:0xf
    v_sub_u32 v196, v230, v229
    v_readlane_b32 s50, v230, 63
    v_add_u32 v197, v196, v231
    v_lshlrev_b32 v238, 2, v196
    v_lshlrev_b32 v239, 2, v197
    ds_write_b64 v227, v[238:239] offset:1024
    v_mov_b32 v198, v197
    v_add_u32 v199, v197, v232
    s_add_u32 s50, s50, 127
    s_lshr_b32 s50, s50, 7
    s_lshr_b32 s49, s50, 1
    s_sub_u32 s50, s50, s49
    s_lshl_b32 s35, s50, 2
    s_lshl_b32 s36, s49, 2
    s_sub_u32 s37, s35, s36
    s_lshl_b32 s37, s37, 3
    s_cmp_lt_u32 s28, 4
    s_cselect_b32 s33, s35, s36
    s_cselect_b32 s37, 0, s37
    s_lshr_b32 s34, s33, 2
    s_sub_u32 s34, s34, 1
    v_max_u32 v240, v231, v232
    s_lshl_b32 s49, s28, 2
    v_add_u32 v227, s49, v196
    v_add_u32 v228, s49, v197
    v_add_u32 v229, 784, v200
K2_QFS:
    s_add_u32 s50, s49, 4
    v_cmp_eq_u32 s[54:55], s50, v231
    v_cmp_eq_u32 s[56:57], s50, v232
    v_mov_b32 v233, v200
    v_mov_b32 v234, v229
    v_or_b32 v230, 0x80000000, v233
    v_or_b32 v235, 0x80000000, v234
    v_cmp_lt_u32 vcc, s49, v231
    v_cndmask_b32 v233, v233, v230, s[54:55]
    v_cndmask_b32 v234, v234, v235, s[56:57]
    v_cmp_lt_u32 s[54:55], s49, v232
    s_mov_b64 exec, vcc
    ds_write_b32 v227, v233 offset:1536
    s_mov_b64 exec, s[54:55]
    ds_write_b32 v228, v234 offset:1536
    s_mov_b64 exec, -1
    s_add_u32 s49, s49, 32
    v_add_u32 v227, 32, v227
    v_add_u32 v228, 32, v228
    v_cmp_lt_u32 vcc, s49, v240
    s_cbranch_vccnz K2_QFS
    s_waitcnt lgkmcnt(0)
    s_mov_b64 exec, s[60:61]
    ds_read_b32 v68, v149 offset:1024
    s_mov_b64 exec, s[62:63]
    ds_read_b32 v69, v151 offset:1024
    s_mov_b64 exec, s[64:65]
    ds_read_b32 v70, v153 offset:1024
    s_mov_b64 exec, s[66:67]
    ds_read_b32 v71, v155 offset:1024
    s_mov_b64 exec, s[68:69]
    ds_read_b32 v72, v157 offset:1024
    s_mov_b64 exec, s[70:71]
    ds_read_b32 v73, v159 offset:1024
    s_mov_b64 exec, s[72:73]
    ds_read_b32 v74, v161 offset:1024
    s_mov_b64 exec, s[74:75]
    ds_read_b32 v75, v163 offset:1024
    s_mov_b64 exec, s[60:61]
    s_waitcnt lgkmcnt(7)
    v_lshl_add_u32 v68, v116, 2, v68
    ds_write_b32 v68, v148 offset:5376
    s_mov_b64 exec, s[62:63]
    s_waitcnt lgkmcnt(7)
    v_lshl_add_u32 v69, v117, 2, v69
    ds_write_b32 v69, v150 offset:5376
    s_mov_b64 exec, s[64:65]
    s_waitcnt lgkmcnt(7)
    v_lshl_add_u32 v70, v118, 2, v70
    ds_write_b32 v70, v152 offset:5376
    s_mov_b64 exec, s[66:67]
    s_waitcnt lgkmcnt(7)
    v_lshl_add_u32 v71, v119, 2, v71
    ds_write_b32 v71, v154 offset:5376
    s_mov_b64 exec, s[68:69]
    s_waitcnt lgkmcnt(7)
    v_lshl_add_u32 v72, v120, 2, v72
    ds_write_b32 v72, v156 offset:5376
    s_mov_b64 exec, s[70:71]
    s_waitcnt lgkmcnt(7)
    v_lshl_add_u32 v73, v121, 2, v73
    ds_write_b32 v73, v158 offset:5376
    s_mov_b64 exec, s[72:73]
    s_waitcnt lgkmcnt(7)
    v_lshl_add_u32 v74, v122, 2, v74
    ds_write_b32 v74, v160 offset:5376
    s_mov_b64 exec, s[74:75]
    s_waitcnt lgkmcnt(7)
    v_lshl_add_u32 v75, v123, 2, v75
    ds_write_b32 v75, v162 offset:5376
    s_mov_b64 exec, s[76:77]
    s_cbranch_execz L_sks_56
    ds_read_b32 v76, v165 offset:1024
    s_mov_b64 exec, s[78:79]
    ds_read_b32 v77, v167 offset:1024
    s_waitcnt lgkmcnt(0)
    v_lshl_add_u32 v77, v125, 2, v77
    ds_write_b32 v77, v166 offset:5376
    s_mov_b64 exec, s[76:77]
    v_lshl_add_u32 v76, v124, 2, v76
    ds_write_b32 v76, v164 offset:5376
L_sks_56:
    s_mov_b64 exec, s[80:81]
    s_cbranch_execz L_sks_57
    ds_read_b32 v78, v169 offset:1024
    s_mov_b64 exec, s[82:83]
    ds_read_b32 v79, v171 offset:1024
    s_waitcnt lgkmcnt(0)
    v_lshl_add_u32 v79, v127, 2, v79
    ds_write_b32 v79, v170 offset:5376
    s_mov_b64 exec, s[80:81]
    v_lshl_add_u32 v78, v126, 2, v78
    ds_write_b32 v78, v168 offset:5376
L_sks_57:
    s_mov_b64 exec, s[84:85]
    s_cbranch_execz L_sks_58
    ds_read_b32 v80, v173 offset:1024
    s_mov_b64 exec, s[86:87]
    ds_read_b32 v81, v175 offset:1024
    s_waitcnt lgkmcnt(0)
    v_lshl_add_u32 v81, v129, 2, v81
    ds_write_b32 v81, v174 offset:5376
    s_mov_b64 exec, s[84:85]
    v_lshl_add_u32 v80, v128, 2, v80
    ds_write_b32 v80, v172 offset:5376
L_sks_58:
    s_mov_b64 exec, s[88:89]
    s_cbranch_execz L_sks_59
    ds_read_b32 v82, v177 offset:1024
    s_mov_b64 exec, s[90:91]
    ds_read_b32 v83, v179 offset:1024
    s_waitcnt lgkmcnt(0)
    v_lshl_add_u32 v83, v131, 2, v83
    ds_write_b32 v83, v178 offset:5376
    s_mov_b64 exec, s[88:89]
    v_lshl_add_u32 v82, v130, 2, v82
    ds_write_b32 v82, v176 offset:5376
L_sks_59:
    s_mov_b64 exec, s[92:93]
    s_cbranch_execz L_sksc_60
    ds_read_b32 v68, v253 offset:1024
    s_mov_b64 exec, s[94:95]
    ds_read_b32 v69, v255 offset:1024
    s_waitcnt lgkmcnt(0)
    v_lshl_add_u32 v69, v226, 2, v69
    ds_write_b32 v69, v254 offset:5376
    s_mov_b64 exec, s[92:93]
    v_lshl_add_u32 v68, v225, 2, v68
    ds_write_b32 v68, v252 offset:5376
L_sksc_60:
    s_mov_b64 exec, -1
    s_waitcnt lgkmcnt(0)
    s_barrier
    s_cmp_eq_u32 s33, 0
    s_cbranch_scc1 K2_SNEXT
    v_add_u32 v228, s37, v245
    v_mad_u32_u24 v227, v244, s33, v228
    v_lshlrev_b32 v216, 4, v227
    ds_read_b128 v[204:207], v216 offset:5376
    v_lshlrev_b32 v219, 2, v227
    v_sub_u32 v218, v227, v245
    v_lshlrev_b32 v218, 2, v218
    v_add_u32 v218, 1536, v218
    v_mad_u32_u24 v227, v246, s33, v228
    v_lshl_add_u32 v217, v227, 4, v247
    s_mov_b32 m0, s58
    s_waitcnt lgkmcnt(0)
    v_mad_u32_u16 v204, v204, s46, v212
    v_mad_u32_u16 v205, v205, s46, v213
    v_mad_u32_u16 v206, v206, s46, v214
    v_mad_u32_u16 v207, v207, s46, v215
    buffer_load_dwordx4 v204, s[12:15], 0 offen lds
    buffer_load_dwordx4 v205, s[12:15], 0 offen offset:1024 lds
    buffer_load_dwordx4 v206, s[12:15], 0 offen offset:2048 lds
    buffer_load_dwordx4 v207, s[12:15], 0 offen offset:3072 lds
    s_sub_u32 s50, s33, 1
    s_lshl_b32 s50, s50, 2
    v_add_u32 v228, s50, v218
    v_mov_b32 v227, 0x80000000
    s_mov_b32 exec_lo, 1
    s_mov_b32 exec_hi, 1
    ds_or_b32 v228, v227
    s_mov_b64 exec, -1
    ds_read_b128 v[196:199], v218
    ds_read_b32 v224, v219 offset:1536
    ds_read_b32 v223, v217 offset:5376
    ds_read_b128 v[204:207], v216 offset:5440
    v_mov_b64 v[172:173], 0
    v_mov_b64 v[176:177], 0
    v_mov_b64 v[174:175], 0
    v_mov_b64 v[178:179], 0
    v_mov_b32 v148, 1.0
    v_mov_b32 v228, 1.0
    v_mov_b32 v149, 1.0
    v_mov_b32 v229, 1.0
    v_mov_b32 v150, 1.0
    v_mov_b32 v230, 1.0
    v_mov_b32 v151, 1.0
    v_mov_b32 v231, 1.0
    v_mov_b32 v152, 1.0
    v_mov_b32 v232, 1.0
    v_mov_b32 v153, 1.0
    v_mov_b32 v233, 1.0
    v_mov_b32 v154, 1.0
    v_mov_b32 v234, 1.0
    v_mov_b32 v155, 1.0
    v_mov_b32 v235, 1.0
    v_mov_b64 v[156:157], 0
    v_mov_b64 v[164:165], 0
    v_mov_b64 v[236:237], 0
    v_mov_b64 v[244:245], 0
    v_mov_b64 v[158:159], 0
    v_mov_b64 v[166:167], 0
    v_mov_b64 v[238:239], 0
    v_mov_b64 v[246:247], 0
    v_mov_b64 v[160:161], 0
    v_mov_b64 v[168:169], 0
    v_mov_b64 v[240:241], 0
    v_mov_b64 v[248:249], 0
    v_mov_b64 v[162:163], 0
    v_mov_b64 v[170:171], 0
    v_mov_b64 v[242:243], 0
    v_mov_b64 v[250:251], 0
    s_mov_b32 s45, 0
    s_waitcnt lgkmcnt(0)
    v_mad_u32_u24 v196, v196, 1, v220
    v_mad_u32_u24 v197, v197, 1, v220
    v_mad_u32_u24 v198, v198, 1, v220
    v_mad_u32_u24 v199, v199, 1, v220
    ds_read_b32 v192, v196 offset:512
    ds_read_b32 v189, v197 offset:512
    ds_read_b32 v190, v198 offset:512
    ds_read_b32 v191, v199 offset:512
    v_perm_b32 v180, v223, v180, v221
    v_perm_b32 v184, v223, v184, v222
    v_cmp_gt_i32 s[40:41], 0, v224
    v_mad_u32_u16 v204, v204, s46, v212
    v_mad_u32_u16 v205, v205, s46, v213
    v_mad_u32_u16 v206, v206, s46, v214
    v_mad_u32_u16 v207, v207, s46, v215
    s_waitcnt vmcnt(0)
    ds_read_b128 v[68:71], v208
    ds_read_b128 v[72:75], v209
    ds_read_b128 v[76:79], v210
    ds_read_b128 v[80:83], v211
    s_or_b32 s44, s40, s41
    s_waitcnt lgkmcnt(0)
    v_and_or_b32 v188, v192, s47, v2
    buffer_load_dwordx4 v204, s[12:15], 0 offen lds
    buffer_load_dwordx4 v205, s[12:15], 0 offen offset:1024 lds
    buffer_load_dwordx4 v206, s[12:15], 0 offen offset:2048 lds
    buffer_load_dwordx4 v207, s[12:15], 0 offen offset:3072 lds
    ds_read_b128 v[204:207], v216 offset:5504
    v_mfma_f32_32x32x16_bf16 v[100:115], v[68:71], v[36:39], 0
    v_mfma_f32_32x32x16_bf16 v[84:99], v[68:71], v[4:7], 0
    v_mfma_f32_32x32x16_bf16 v[100:115], v[72:75], v[40:43], v[100:115]
    v_mfma_f32_32x32x16_bf16 v[84:99], v[72:75], v[8:11], v[84:99]
    v_mfma_f32_32x32x16_bf16 v[100:115], v[76:79], v[44:47], v[100:115]
    v_mfma_f32_32x32x16_bf16 v[84:99], v[76:79], v[12:15], v[84:99]
    v_mfma_f32_32x32x16_bf16 v[100:115], v[80:83], v[48:51], v[100:115]
    v_mfma_f32_32x32x16_bf16 v[84:99], v[80:83], v[16:19], v[84:99]
    v_mfma_f32_32x32x16_bf16 v[84:99], v[180:183], v[188:191], v[84:99]
    s_waitcnt lgkmcnt(0)
    s_nop 7
    s_nop 3
    s_add_u32 s49, s34, 1
    s_mul_i32 s49, s49, 20
    s_lshr_b32 s49, s49, 6
    s_lshl_b32 s49, s49, 1
    s_sub_u32 s59, s34, s49
    s_cmp_ge_u32 s28, 4
    s_cbranch_scc0 K2_PR0S
    s_setprio 1
K2_PR0S:
K2_T0S:
    s_cmp_eq_u32 s34, s59
    s_cbranch_scc1 K2_SWPS
K2_SWBS:
    v_mfma_f32_32x32x16_bf16 v[132:147], v[68:71], v[52:55], 0
    v_rcp_f32 v228, v228
    ds_read_b32 v224, v219 offset:1552
    v_rcp_f32 v229, v229
    ds_read_b32 v223, v217 offset:5440
    v_rcp_f32 v230, v230
    v_mfma_f32_32x32x16_bf16 v[116:131], v[68:71], v[20:23], 0
    v_rcp_f32 v231, v231
    v_and_or_b32 v188, v192, s48, v3
    v_rcp_f32 v232, v232
    v_rcp_f32 v233, v233
    v_mfma_f32_32x32x16_bf16 v[132:147], v[72:75], v[56:59], v[132:147]
    v_rcp_f32 v234, v234
    v_mad_u32_u16 v204, v204, s46, v212
    v_rcp_f32 v235, v235
    v_exp_f32 v84, v84
    v_mfma_f32_32x32x16_bf16 v[116:131], v[72:75], v[24:27], v[116:131]
    v_exp_f32 v85, v85
    v_mad_u32_u16 v205, v205, s46, v213
    v_exp_f32 v86, v86
    v_exp_f32 v87, v87
    v_mfma_f32_32x32x16_bf16 v[132:147], v[76:79], v[60:63], v[132:147]
    v_exp_f32 v88, v88
    v_mad_u32_u16 v206, v206, s46, v214
    v_exp_f32 v89, v89
    v_exp_f32 v90, v90
    v_mfma_f32_32x32x16_bf16 v[116:131], v[76:79], v[28:31], v[116:131]
    v_exp_f32 v91, v91
    v_mad_u32_u16 v207, v207, s46, v215
    v_exp_f32 v92, v92
    v_exp_f32 v93, v93
    v_mfma_f32_32x32x16_bf16 v[132:147], v[80:83], v[64:67], v[132:147]
    v_exp_f32 v94, v94
    v_exp_f32 v95, v95
    v_mfma_f32_32x32x16_bf16 v[116:131], v[80:83], v[32:35], v[116:131]
    v_exp_f32 v96, v96
    v_exp_f32 v97, v97
    v_mfma_f32_32x32x16_bf16 v[116:131], v[184:187], v[188:191], v[116:131]
    v_exp_f32 v98, v98
    v_exp_f32 v99, v99
    s_waitcnt vmcnt(0)
    ds_read_b128 v[68:71], v208
    ds_read_b128 v[72:75], v209
    ds_read_b128 v[76:79], v210
    ds_read_b128 v[80:83], v211
    v_pk_fma_f32 v[176:177], v[148:149], v[156:157], v[176:177]
    v_pk_fma_f32 v[172:173], v[148:149], v[164:165], v[172:173]
    v_pk_fma_f32 v[178:179], v[228:229], v[236:237], v[178:179]
    v_pk_fma_f32 v[174:175], v[228:229], v[244:245], v[174:175]
    s_bitcmp1_b32 s45, 0
    s_cbranch_scc1 L_fl_61
L_bk_62:
    v_pk_fma_f32 v[176:177], v[150:151], v[158:159], v[176:177]
    v_pk_fma_f32 v[172:173], v[150:151], v[166:167], v[172:173]
    v_pk_fma_f32 v[178:179], v[230:231], v[238:239], v[178:179]
    v_pk_fma_f32 v[174:175], v[230:231], v[246:247], v[174:175]
    s_bitcmp1_b32 s45, 8
    s_cbranch_scc1 L_fl_63
L_bk_64:
    v_pk_fma_f32 v[176:177], v[152:153], v[160:161], v[176:177]
    v_pk_fma_f32 v[172:173], v[152:153], v[168:169], v[172:173]
    v_pk_fma_f32 v[178:179], v[232:233], v[240:241], v[178:179]
    v_pk_fma_f32 v[174:175], v[232:233], v[248:249], v[174:175]
    s_bitcmp1_b32 s45, 16
    s_cbranch_scc1 L_fl_65
L_bk_66:
    v_pk_fma_f32 v[176:177], v[154:155], v[162:163], v[176:177]
    v_pk_fma_f32 v[172:173], v[154:155], v[170:171], v[172:173]
    v_pk_fma_f32 v[178:179], v[234:235], v[242:243], v[178:179]
    v_pk_fma_f32 v[174:175], v[234:235], v[250:251], v[174:175]
    s_bitcmp1_b32 s45, 24
    s_cbranch_scc1 L_fl_67
L_bk_68:
    ds_read_b128 v[200:203], v218 offset:16
    v_pk_fma_f32 v[84:85], v[84:85], s[38:39], s[38:39] clamp
    v_pk_fma_f32 v[86:87], v[86:87], s[38:39], s[38:39] clamp
    v_pk_fma_f32 v[88:89], v[88:89], s[38:39], s[38:39] clamp
    v_pk_fma_f32 v[90:91], v[90:91], s[38:39], s[38:39] clamp
    v_pk_fma_f32 v[92:93], v[92:93], s[38:39], s[38:39] clamp
    v_pk_fma_f32 v[94:95], v[94:95], s[38:39], s[38:39] clamp
    v_pk_fma_f32 v[96:97], v[96:97], s[38:39], s[38:39] clamp
    v_pk_fma_f32 v[98:99], v[98:99], s[38:39], s[38:39] clamp
    v_pk_mul_f32 v[156:157], v[86:87], v[100:101]
    v_pk_mul_f32 v[148:149], v[84:85], v[86:87]
    v_pk_add_f32 v[164:165], v[84:85], v[86:87]
    v_pk_fma_f32 v[156:157], v[84:85], v[102:103], v[156:157]
    v_pk_mul_f32 v[158:159], v[90:91], v[104:105]
    v_pk_mul_f32 v[150:151], v[88:89], v[90:91]
    v_pk_add_f32 v[166:167], v[88:89], v[90:91]
    v_pk_fma_f32 v[158:159], v[88:89], v[106:107], v[158:159]
    v_pk_mul_f32 v[160:161], v[94:95], v[108:109]
    v_pk_mul_f32 v[152:153], v[92:93], v[94:95]
    v_pk_add_f32 v[168:169], v[92:93], v[94:95]
    v_pk_fma_f32 v[160:161], v[92:93], v[110:111], v[160:161]
    v_pk_mul_f32 v[162:163], v[98:99], v[112:113]
    v_pk_mul_f32 v[154:155], v[96:97], v[98:99]
    v_pk_add_f32 v[170:171], v[96:97], v[98:99]
    v_pk_fma_f32 v[162:163], v[96:97], v[114:115], v[162:163]
    s_sub_u32 s34, s34, 1
    s_cbranch_scc1 K2_E0S
    s_waitcnt lgkmcnt(0)
    v_mfma_f32_32x32x16_bf16 v[100:115], v[68:71], v[36:39], 0
    v_rcp_f32 v148, v148
    v_mad_u32_u24 v200, v200, 1, v220
    buffer_load_dwordx4 v204, s[12:15], 0 offen lds
    v_rcp_f32 v149, v149
    v_mad_u32_u24 v201, v201, 1, v220
    buffer_load_dwordx4 v205, s[12:15], 0 offen offset:1024 lds
    v_rcp_f32 v150, v150
    ds_read_b32 v192, v200 offset:512
    buffer_load_dwordx4 v206, s[12:15], 0 offen offset:2048 lds
    v_mfma_f32_32x32x16_bf16 v[84:99], v[68:71], v[4:7], 0
    v_rcp_f32 v151, v151
    v_mad_u32_u24 v202, v202, 1, v220
    ds_read_b32 v189, v201 offset:512
    buffer_load_dwordx4 v207, s[12:15], 0 offen offset:3072 lds
    v_rcp_f32 v152, v152
    v_mad_u32_u24 v203, v203, 1, v220
    ds_read_b32 v190, v202 offset:512
    v_rcp_f32 v153, v153
    ds_read_b32 v191, v203 offset:512
    v_mfma_f32_32x32x16_bf16 v[100:115], v[72:75], v[40:43], v[100:115]
    v_rcp_f32 v154, v154
    ds_read_b128 v[204:207], v216 offset:5568
    v_rcp_f32 v155, v155
    v_perm_b32 v180, v223, v180, v221
    v_exp_f32 v116, v116
    v_mfma_f32_32x32x16_bf16 v[84:99], v[72:75], v[8:11], v[84:99]
    v_exp_f32 v117, v117
    v_perm_b32 v184, v223, v184, v222
    v_exp_f32 v118, v118
    v_exp_f32 v119, v119
    v_cmp_gt_i32 s[42:43], 0, v224
    v_mfma_f32_32x32x16_bf16 v[100:115], v[76:79], v[44:47], v[100:115]
    v_exp_f32 v120, v120
    v_exp_f32 v121, v121
    v_exp_f32 v122, v122
    v_mfma_f32_32x32x16_bf16 v[84:99], v[76:79], v[12:15], v[84:99]
    v_exp_f32 v123, v123
    v_exp_f32 v124, v124
    v_exp_f32 v125, v125
    s_or_b32 s45, s42, s43
    v_mfma_f32_32x32x16_bf16 v[100:115], v[80:83], v[48:51], v[100:115]
    v_exp_f32 v126, v126
    v_exp_f32 v127, v127
    s_waitcnt lgkmcnt(0)
    v_and_or_b32 v188, v192, s47, v2
    v_mfma_f32_32x32x16_bf16 v[84:99], v[80:83], v[16:19], v[84:99]
    v_exp_f32 v128, v128
    v_exp_f32 v129, v129
    v_mfma_f32_32x32x16_bf16 v[84:99], v[180:183], v[188:191], v[84:99]
    v_exp_f32 v130, v130
    v_exp_f32 v131, v131
    v_pk_fma_f32 v[116:117], v[116:117], s[38:39], s[38:39] clamp
    v_pk_fma_f32 v[118:119], v[118:119], s[38:39], s[38:39] clamp
    v_pk_fma_f32 v[120:121], v[120:121], s[38:39], s[38:39] clamp
    v_pk_fma_f32 v[122:123], v[122:123], s[38:39], s[38:39] clamp
    v_pk_fma_f32 v[124:125], v[124:125], s[38:39], s[38:39] clamp
    v_pk_fma_f32 v[126:127], v[126:127], s[38:39], s[38:39] clamp
    v_pk_fma_f32 v[128:129], v[128:129], s[38:39], s[38:39] clamp
    v_pk_fma_f32 v[130:131], v[130:131], s[38:39], s[38:39] clamp
    v_pk_mul_f32 v[236:237], v[118:119], v[132:133]
    v_pk_mul_f32 v[228:229], v[116:117], v[118:119]
    v_pk_add_f32 v[244:245], v[116:117], v[118:119]
    v_pk_fma_f32 v[236:237], v[116:117], v[134:135], v[236:237]
    v_pk_mul_f32 v[238:239], v[122:123], v[136:137]
    v_pk_mul_f32 v[230:231], v[120:121], v[122:123]
    v_pk_add_f32 v[246:247], v[120:121], v[122:123]
    v_pk_fma_f32 v[238:239], v[120:121], v[138:139], v[238:239]
    v_pk_mul_f32 v[240:241], v[126:127], v[140:141]
    v_pk_mul_f32 v[232:233], v[124:125], v[126:127]
    v_pk_add_f32 v[248:249], v[124:125], v[126:127]
    v_pk_fma_f32 v[240:241], v[124:125], v[142:143], v[240:241]
    v_pk_mul_f32 v[242:243], v[130:131], v[144:145]
    v_pk_mul_f32 v[234:235], v[128:129], v[130:131]
    v_pk_add_f32 v[250:251], v[128:129], v[130:131]
    v_pk_fma_f32 v[242:243], v[128:129], v[146:147], v[242:243]
    v_mfma_f32_32x32x16_bf16 v[132:147], v[68:71], v[52:55], 0
    v_rcp_f32 v228, v228
    ds_read_b32 v224, v219 offset:1568
    v_rcp_f32 v229, v229
    ds_read_b32 v223, v217 offset:5504
    v_rcp_f32 v230, v230
    v_mfma_f32_32x32x16_bf16 v[116:131], v[68:71], v[20:23], 0
    v_rcp_f32 v231, v231
    v_and_or_b32 v188, v192, s48, v3
    v_rcp_f32 v232, v232
    v_rcp_f32 v233, v233
    v_mfma_f32_32x32x16_bf16 v[132:147], v[72:75], v[56:59], v[132:147]
    v_rcp_f32 v234, v234
    v_mad_u32_u16 v204, v204, s46, v212
    v_rcp_f32 v235, v235
    v_exp_f32 v84, v84
    v_mfma_f32_32x32x16_bf16 v[116:131], v[72:75], v[24:27], v[116:131]
    v_exp_f32 v85, v85
    v_mad_u32_u16 v205, v205, s46, v213
    v_exp_f32 v86, v86
    v_exp_f32 v87, v87
    v_mfma_f32_32x32x16_bf16 v[132:147], v[76:79], v[60:63], v[132:147]
    v_exp_f32 v88, v88
    v_mad_u32_u16 v206, v206, s46, v214
    v_exp_f32 v89, v89
    v_exp_f32 v90, v90
    v_mfma_f32_32x32x16_bf16 v[116:131], v[76:79], v[28:31], v[116:131]
    v_exp_f32 v91, v91
    v_mad_u32_u16 v207, v207, s46, v215
    v_exp_f32 v92, v92
    v_exp_f32 v93, v93
    v_mfma_f32_32x32x16_bf16 v[132:147], v[80:83], v[64:67], v[132:147]
    v_exp_f32 v94, v94
    v_exp_f32 v95, v95
    v_mfma_f32_32x32x16_bf16 v[116:131], v[80:83], v[32:35], v[116:131]
    v_exp_f32 v96, v96
    v_exp_f32 v97, v97
    v_mfma_f32_32x32x16_bf16 v[116:131], v[184:187], v[188:191], v[116:131]
    v_exp_f32 v98, v98
    v_exp_f32 v99, v99
    s_waitcnt vmcnt(0)
    ds_read_b128 v[68:71], v208
    ds_read_b128 v[72:75], v209
    ds_read_b128 v[76:79], v210
    ds_read_b128 v[80:83], v211
    v_pk_fma_f32 v[176:177], v[148:149], v[156:157], v[176:177]
    v_pk_fma_f32 v[172:173], v[148:149], v[164:165], v[172:173]
    v_pk_fma_f32 v[178:179], v[228:229], v[236:237], v[178:179]
    v_pk_fma_f32 v[174:175], v[228:229], v[244:245], v[174:175]
    s_bitcmp1_b32 s44, 0
    s_cbranch_scc1 L_fl_69
L_bk_70:
    v_pk_fma_f32 v[176:177], v[150:151], v[158:159], v[176:177]
    v_pk_fma_f32 v[172:173], v[150:151], v[166:167], v[172:173]
    v_pk_fma_f32 v[178:179], v[230:231], v[238:239], v[178:179]
    v_pk_fma_f32 v[174:175], v[230:231], v[246:247], v[174:175]
    s_bitcmp1_b32 s44, 8
    s_cbranch_scc1 L_fl_71
L_bk_72:
    v_pk_fma_f32 v[176:177], v[152:153], v[160:161], v[176:177]
    v_pk_fma_f32 v[172:173], v[152:153], v[168:169], v[172:173]
    v_pk_fma_f32 v[178:179], v[232:233], v[240:241], v[178:179]
    v_pk_fma_f32 v[174:175], v[232:233], v[248:249], v[174:175]
    s_bitcmp1_b32 s44, 16
    s_cbranch_scc1 L_fl_73
L_bk_74:
    v_pk_fma_f32 v[176:177], v[154:155], v[162:163], v[176:177]
    v_pk_fma_f32 v[172:173], v[154:155], v[170:171], v[172:173]
    v_pk_fma_f32 v[178:179], v[234:235], v[242:243], v[178:179]
    v_pk_fma_f32 v[174:175], v[234:235], v[250:251], v[174:175]
    s_bitcmp1_b32 s44, 24
    s_cbranch_scc1 L_fl_75
L_bk_76:
    ds_read_b128 v[196:199], v218 offset:32
    v_pk_fma_f32 v[84:85], v[84:85], s[38:39], s[38:39] clamp
    v_pk_fma_f32 v[86:87], v[86:87], s[38:39], s[38:39] clamp
    v_pk_fma_f32 v[88:89], v[88:89], s[38:39], s[38:39] clamp
    v_pk_fma_f32 v[90:91], v[90:91], s[38:39], s[38:39] clamp
    v_pk_fma_f32 v[92:93], v[92:93], s[38:39], s[38:39] clamp
    v_pk_fma_f32 v[94:95], v[94:95], s[38:39], s[38:39] clamp
    v_pk_fma_f32 v[96:97], v[96:97], s[38:39], s[38:39] clamp
    v_pk_fma_f32 v[98:99], v[98:99], s[38:39], s[38:39] clamp
    v_pk_mul_f32 v[156:157], v[86:87], v[100:101]
    v_pk_mul_f32 v[148:149], v[84:85], v[86:87]
    v_pk_add_f32 v[164:165], v[84:85], v[86:87]
    v_pk_fma_f32 v[156:157], v[84:85], v[102:103], v[156:157]
    v_pk_mul_f32 v[158:159], v[90:91], v[104:105]
    v_pk_mul_f32 v[150:151], v[88:89], v[90:91]
    v_pk_add_f32 v[166:167], v[88:89], v[90:91]
    v_pk_fma_f32 v[158:159], v[88:89], v[106:107], v[158:159]
    v_pk_mul_f32 v[160:161], v[94:95], v[108:109]
    v_pk_mul_f32 v[152:153], v[92:93], v[94:95]
    v_pk_add_f32 v[168:169], v[92:93], v[94:95]
    v_pk_fma_f32 v[160:161], v[92:93], v[110:111], v[160:161]
    v_pk_mul_f32 v[162:163], v[98:99], v[112:113]
    v_pk_mul_f32 v[154:155], v[96:97], v[98:99]
    v_pk_add_f32 v[170:171], v[96:97], v[98:99]
    v_pk_fma_f32 v[162:163], v[96:97], v[114:115], v[162:163]
    s_sub_u32 s34, s34, 1
    s_cbranch_scc1 K2_E1S
    s_waitcnt lgkmcnt(0)
    v_mfma_f32_32x32x16_bf16 v[100:115], v[68:71], v[36:39], 0
    v_rcp_f32 v148, v148
    v_mad_u32_u24 v196, v196, 1, v220
    buffer_load_dwordx4 v204, s[12:15], 0 offen lds
    v_rcp_f32 v149, v149
    v_mad_u32_u24 v197, v197, 1, v220
    buffer_load_dwordx4 v205, s[12:15], 0 offen offset:1024 lds
    v_rcp_f32 v150, v150
    ds_read_b32 v192, v196 offset:512
    buffer_load_dwordx4 v206, s[12:15], 0 offen offset:2048 lds
    v_mfma_f32_32x32x16_bf16 v[84:99], v[68:71], v[4:7], 0
    v_rcp_f32 v151, v151
    v_mad_u32_u24 v198, v198, 1, v220
    ds_read_b32 v189, v197 offset:512
    buffer_load_dwordx4 v207, s[12:15], 0 offen offset:3072 lds
    v_rcp_f32 v152, v152
    v_mad_u32_u24 v199, v199, 1, v220
    ds_read_b32 v190, v198 offset:512
    v_rcp_f32 v153, v153
    ds_read_b32 v191, v199 offset:512
    v_mfma_f32_32x32x16_bf16 v[100:115], v[72:75], v[40:43], v[100:115]
    v_rcp_f32 v154, v154
    ds_read_b128 v[204:207], v216 offset:5632
    v_rcp_f32 v155, v155
    v_perm_b32 v180, v223, v180, v221
    v_exp_f32 v116, v116
    v_mfma_f32_32x32x16_bf16 v[84:99], v[72:75], v[8:11], v[84:99]
    v_exp_f32 v117, v117
    v_perm_b32 v184, v223, v184, v222
    v_exp_f32 v118, v118
    v_exp_f32 v119, v119
    v_cmp_gt_i32 s[40:41], 0, v224
    v_mfma_f32_32x32x16_bf16 v[100:115], v[76:79], v[44:47], v[100:115]
    v_exp_f32 v120, v120
    v_exp_f32 v121, v121
    v_add_u32 v218, 32, v218
    v_exp_f32 v122, v122
    v_add_u32 v219, 32, v219
    v_mfma_f32_32x32x16_bf16 v[84:99], v[76:79], v[12:15], v[84:99]
    v_exp_f32 v123, v123
    v_add_u32 v217, 128, v217
    v_exp_f32 v124, v124
    v_add_u32 v216, 128, v216
    v_exp_f32 v125, v125
    s_or_b32 s44, s40, s41
    v_mfma_f32_32x32x16_bf16 v[100:115], v[80:83], v[48:51], v[100:115]
    v_exp_f32 v126, v126
    v_exp_f32 v127, v127
    s_waitcnt lgkmcnt(0)
    v_and_or_b32 v188, v192, s47, v2
    v_mfma_f32_32x32x16_bf16 v[84:99], v[80:83], v[16:19], v[84:99]
    v_exp_f32 v128, v128
    v_exp_f32 v129, v129
    v_mfma_f32_32x32x16_bf16 v[84:99], v[180:183], v[188:191], v[84:99]
    v_exp_f32 v130, v130
    v_exp_f32 v131, v131
    v_pk_fma_f32 v[116:117], v[116:117], s[38:39], s[38:39] clamp
    v_pk_fma_f32 v[118:119], v[118:119], s[38:39], s[38:39] clamp
    v_pk_fma_f32 v[120:121], v[120:121], s[38:39], s[38:39] clamp
    v_pk_fma_f32 v[122:123], v[122:123], s[38:39], s[38:39] clamp
    v_pk_fma_f32 v[124:125], v[124:125], s[38:39], s[38:39] clamp
    v_pk_fma_f32 v[126:127], v[126:127], s[38:39], s[38:39] clamp
    v_pk_fma_f32 v[128:129], v[128:129], s[38:39], s[38:39] clamp
    v_pk_fma_f32 v[130:131], v[130:131], s[38:39], s[38:39] clamp
    v_pk_mul_f32 v[236:237], v[118:119], v[132:133]
    v_pk_mul_f32 v[228:229], v[116:117], v[118:119]
    v_pk_add_f32 v[244:245], v[116:117], v[118:119]
    v_pk_fma_f32 v[236:237], v[116:117], v[134:135], v[236:237]
    v_pk_mul_f32 v[238:239], v[122:123], v[136:137]
    v_pk_mul_f32 v[230:231], v[120:121], v[122:123]
    v_pk_add_f32 v[246:247], v[120:121], v[122:123]
    v_pk_fma_f32 v[238:239], v[120:121], v[138:139], v[238:239]
    v_pk_mul_f32 v[240:241], v[126:127], v[140:141]
    v_pk_mul_f32 v[232:233], v[124:125], v[126:127]
    v_pk_add_f32 v[248:249], v[124:125], v[126:127]
    v_pk_fma_f32 v[240:241], v[124:125], v[142:143], v[240:241]
    v_pk_mul_f32 v[242:243], v[130:131], v[144:145]
    v_pk_mul_f32 v[234:235], v[128:129], v[130:131]
    v_pk_add_f32 v[250:251], v[128:129], v[130:131]
    v_pk_fma_f32 v[242:243], v[128:129], v[146:147], v[242:243]
    s_branch K2_T0S
K2_E0S:
    v_rcp_f32 v148, v148
    v_rcp_f32 v149, v149
    v_rcp_f32 v150, v150
    v_rcp_f32 v151, v151
    v_rcp_f32 v152, v152
    v_rcp_f32 v153, v153
    v_rcp_f32 v154, v154
    v_rcp_f32 v155, v155
    v_exp_f32 v116, v116
    v_exp_f32 v117, v117
    v_exp_f32 v118, v118
    v_exp_f32 v119, v119
    v_exp_f32 v120, v120
    v_exp_f32 v121, v121
    v_exp_f32 v122, v122
    v_exp_f32 v123, v123
    v_exp_f32 v124, v124
    v_exp_f32 v125, v125
    v_exp_f32 v126, v126
    v_exp_f32 v127, v127
    v_exp_f32 v128, v128
    v_exp_f32 v129, v129
    v_exp_f32 v130, v130
    v_exp_f32 v131, v131
    v_pk_fma_f32 v[116:117], v[116:117], s[38:39], s[38:39] clamp
    v_pk_fma_f32 v[118:119], v[118:119], s[38:39], s[38:39] clamp
    v_pk_fma_f32 v[120:121], v[120:121], s[38:39], s[38:39] clamp
    v_pk_fma_f32 v[122:123], v[122:123], s[38:39], s[38:39] clamp
    v_pk_fma_f32 v[124:125], v[124:125], s[38:39], s[38:39] clamp
    v_pk_fma_f32 v[126:127], v[126:127], s[38:39], s[38:39] clamp
    v_pk_fma_f32 v[128:129], v[128:129], s[38:39], s[38:39] clamp
    v_pk_fma_f32 v[130:131], v[130:131], s[38:39], s[38:39] clamp
    v_pk_mul_f32 v[236:237], v[118:119], v[132:133]
    v_pk_mul_f32 v[228:229], v[116:117], v[118:119]
    v_pk_add_f32 v[244:245], v[116:117], v[118:119]
    v_pk_fma_f32 v[236:237], v[116:117], v[134:135], v[236:237]
    v_pk_mul_f32 v[238:239], v[122:123], v[136:137]
    v_pk_mul_f32 v[230:231], v[120:121], v[122:123]
    v_pk_add_f32 v[246:247], v[120:121], v[122:123]
    v_pk_fma_f32 v[238:239], v[120:121], v[138:139], v[238:239]
    v_pk_mul_f32 v[240:241], v[126:127], v[140:141]
    v_pk_mul_f32 v[232:233], v[124:125], v[126:127]
    v_pk_add_f32 v[248:249], v[124:125], v[126:127]
    v_pk_fma_f32 v[240:241], v[124:125], v[142:143], v[240:241]
    v_pk_mul_f32 v[242:243], v[130:131], v[144:145]
    v_pk_mul_f32 v[234:235], v[128:129], v[130:131]
    v_pk_add_f32 v[250:251], v[128:129], v[130:131]
    v_pk_fma_f32 v[242:243], v[128:129], v[146:147], v[242:243]
    v_rcp_f32 v228, v228
    v_rcp_f32 v229, v229
    v_rcp_f32 v230, v230
    v_rcp_f32 v231, v231
    v_rcp_f32 v232, v232
    v_rcp_f32 v233, v233
    v_rcp_f32 v234, v234
    v_rcp_f32 v235, v235
    s_nop 0
    v_pk_fma_f32 v[176:177], v[148:149], v[156:157], v[176:177]
    v_pk_fma_f32 v[172:173], v[148:149], v[164:165], v[172:173]
    v_pk_fma_f32 v[178:179], v[228:229], v[236:237], v[178:179]
    v_pk_fma_f32 v[174:175], v[228:229], v[244:245], v[174:175]
    s_bitcmp1_b32 s44, 0
    s_cbranch_scc1 L_fl_77
L_bk_78:
    v_pk_fma_f32 v[176:177], v[150:151], v[158:159], v[176:177]
    v_pk_fma_f32 v[172:173], v[150:151], v[166:167], v[172:173]
    v_pk_fma_f32 v[178:179], v[230:231], v[238:239], v[178:179]
    v_pk_fma_f32 v[174:175], v[230:231], v[246:247], v[174:175]
    s_bitcmp1_b32 s44, 8
    s_cbranch_scc1 L_fl_79
L_bk_80:
    v_pk_fma_f32 v[176:177], v[152:153], v[160:161], v[176:177]
    v_pk_fma_f32 v[172:173], v[152:153], v[168:169], v[172:173]
    v_pk_fma_f32 v[178:179], v[232:233], v[240:241], v[178:179]
    v_pk_fma_f32 v[174:175], v[232:233], v[248:249], v[174:175]
    s_bitcmp1_b32 s44, 16
    s_cbranch_scc1 L_fl_81
L_bk_82:
    v_pk_fma_f32 v[176:177], v[154:155], v[162:163], v[176:177]
    v_pk_fma_f32 v[172:173], v[154:155], v[170:171], v[172:173]
    v_pk_fma_f32 v[178:179], v[234:235], v[242:243], v[178:179]
    v_pk_fma_f32 v[174:175], v[234:235], v[250:251], v[174:175]
    s_bitcmp1_b32 s44, 24
    s_cbranch_scc1 L_fl_83
L_bk_84:
    s_branch K2_MDS
K2_E1S:
    v_rcp_f32 v148, v148
    v_rcp_f32 v149, v149
    v_rcp_f32 v150, v150
    v_rcp_f32 v151, v151
    v_rcp_f32 v152, v152
    v_rcp_f32 v153, v153
    v_rcp_f32 v154, v154
    v_rcp_f32 v155, v155
    v_exp_f32 v116, v116
    v_exp_f32 v117, v117
    v_exp_f32 v118, v118
    v_exp_f32 v119, v119
    v_exp_f32 v120, v120
    v_exp_f32 v121, v121
    v_exp_f32 v122, v122
    v_exp_f32 v123, v123
    v_exp_f32 v124, v124
    v_exp_f32 v125, v125
    v_exp_f32 v126, v126
    v_exp_f32 v127, v127
    v_exp_f32 v128, v128
    v_exp_f32 v129, v129
    v_exp_f32 v130, v130
    v_exp_f32 v131, v131
    v_pk_fma_f32 v[116:117], v[116:117], s[38:39], s[38:39] clamp
    v_pk_fma_f32 v[118:119], v[118:119], s[38:39], s[38:39] clamp
    v_pk_fma_f32 v[120:121], v[120:121], s[38:39], s[38:39] clamp
    v_pk_fma_f32 v[122:123], v[122:123], s[38:39], s[38:39] clamp
    v_pk_fma_f32 v[124:125], v[124:125], s[38:39], s[38:39] clamp
    v_pk_fma_f32 v[126:127], v[126:127], s[38:39], s[38:39] clamp
    v_pk_fma_f32 v[128:129], v[128:129], s[38:39], s[38:39] clamp
    v_pk_fma_f32 v[130:131], v[130:131], s[38:39], s[38:39] clamp
    v_pk_mul_f32 v[236:237], v[118:119], v[132:133]
    v_pk_mul_f32 v[228:229], v[116:117], v[118:119]
    v_pk_add_f32 v[244:245], v[116:117], v[118:119]
    v_pk_fma_f32 v[236:237], v[116:117], v[134:135], v[236:237]
    v_pk_mul_f32 v[238:239], v[122:123], v[136:137]
    v_pk_mul_f32 v[230:231], v[120:121], v[122:123]
    v_pk_add_f32 v[246:247], v[120:121], v[122:123]
    v_pk_fma_f32 v[238:239], v[120:121], v[138:139], v[238:239]
    v_pk_mul_f32 v[240:241], v[126:127], v[140:141]
    v_pk_mul_f32 v[232:233], v[124:125], v[126:127]
    v_pk_add_f32 v[248:249], v[124:125], v[126:127]
    v_pk_fma_f32 v[240:241], v[124:125], v[142:143], v[240:241]
    v_pk_mul_f32 v[242:243], v[130:131], v[144:145]
    v_pk_mul_f32 v[234:235], v[128:129], v[130:131]
    v_pk_add_f32 v[250:251], v[128:129], v[130:131]
    v_pk_fma_f32 v[242:243], v[128:129], v[146:147], v[242:243]
    v_rcp_f32 v228, v228
    v_rcp_f32 v229, v229
    v_rcp_f32 v230, v230
    v_rcp_f32 v231, v231
    v_rcp_f32 v232, v232
    v_rcp_f32 v233, v233
    v_rcp_f32 v234, v234
    v_rcp_f32 v235, v235
    s_nop 0
    v_pk_fma_f32 v[176:177], v[148:149], v[156:157], v[176:177]
    v_pk_fma_f32 v[172:173], v[148:149], v[164:165], v[172:173]
    v_pk_fma_f32 v[178:179], v[228:229], v[236:237], v[178:179]
    v_pk_fma_f32 v[174:175], v[228:229], v[244:245], v[174:175]
    s_bitcmp1_b32 s45, 0
    s_cbranch_scc1 L_fl_85
L_bk_86:
    v_pk_fma_f32 v[176:177], v[150:151], v[158:159], v[176:177]
    v_pk_fma_f32 v[172:173], v[150:151], v[166:167], v[172:173]
    v_pk_fma_f32 v[178:179], v[230:231], v[238:239], v[178:179]
    v_pk_fma_f32 v[174:175], v[230:231], v[246:247], v[174:175]
    s_bitcmp1_b32 s45, 8
    s_cbranch_scc1 L_fl_87
L_bk_88:
    v_pk_fma_f32 v[176:177], v[152:153], v[160:161], v[176:177]
    v_pk_fma_f32 v[172:173], v[152:153], v[168:169], v[172:173]
    v_pk_fma_f32 v[178:179], v[232:233], v[240:241], v[178:179]
    v_pk_fma_f32 v[174:175], v[232:233], v[248:249], v[174:175]
    s_bitcmp1_b32 s45, 16
    s_cbranch_scc1 L_fl_89
L_bk_90:
    v_pk_fma_f32 v[176:177], v[154:155], v[162:163], v[176:177]
    v_pk_fma_f32 v[172:173], v[154:155], v[170:171], v[172:173]
    v_pk_fma_f32 v[178:179], v[234:235], v[242:243], v[178:179]
    v_pk_fma_f32 v[174:175], v[234:235], v[250:251], v[174:175]
    s_bitcmp1_b32 s45, 24
    s_cbranch_scc1 L_fl_91
L_bk_92:
    s_branch K2_MDS
K2_SWPS:
    s_cmp_ge_u32 s28, 4
    s_cbranch_scc1 K2_SW0S
    s_setprio 1
    s_branch K2_SWBS
K2_SW0S:
    s_setprio 0
    s_branch K2_SWBS
L_fl_61:
    s_bfe_i32 exec_lo, s42, 0x10000
    s_bfe_i32 exec_hi, s43, 0x10000
    v_add_f32 v225, v172, v173
    v_add_f32 v226, v176, v177
    v_add_f32 v252, v174, v175
    v_add_f32 v227, v178, v179
    v_mov_b64 v[172:173], 0
    v_mov_b64 v[176:177], 0
    ds_add_f32 v200, v225
    ds_add_f32 v200, v226 offset:256
    ds_add_f32 v200, v252 offset:128
    ds_add_f32 v200, v227 offset:384
    v_mov_b64 v[174:175], 0
    v_mov_b64 v[178:179], 0
    s_mov_b64 exec, -1
    s_branch L_bk_62
L_fl_63:
    s_bfe_i32 exec_lo, s42, 0x10008
    s_bfe_i32 exec_hi, s43, 0x10008
    v_add_f32 v225, v172, v173
    v_add_f32 v226, v176, v177
    v_add_f32 v252, v174, v175
    v_add_f32 v227, v178, v179
    v_mov_b64 v[172:173], 0
    v_mov_b64 v[176:177], 0
    ds_add_f32 v201, v225
    ds_add_f32 v201, v226 offset:256
    ds_add_f32 v201, v252 offset:128
    ds_add_f32 v201, v227 offset:384
    v_mov_b64 v[174:175], 0
    v_mov_b64 v[178:179], 0
    s_mov_b64 exec, -1
    s_branch L_bk_64
L_fl_65:
    s_bfe_i32 exec_lo, s42, 0x10010
    s_bfe_i32 exec_hi, s43, 0x10010
    v_add_f32 v225, v172, v173
    v_add_f32 v226, v176, v177
    v_add_f32 v252, v174, v175
    v_add_f32 v227, v178, v179
    v_mov_b64 v[172:173], 0
    v_mov_b64 v[176:177], 0
    ds_add_f32 v202, v225
    ds_add_f32 v202, v226 offset:256
    ds_add_f32 v202, v252 offset:128
    ds_add_f32 v202, v227 offset:384
    v_mov_b64 v[174:175], 0
    v_mov_b64 v[178:179], 0
    s_mov_b64 exec, -1
    s_branch L_bk_66
L_fl_67:
    s_bfe_i32 exec_lo, s42, 0x10018
    s_bfe_i32 exec_hi, s43, 0x10018
    v_add_f32 v225, v172, v173
    v_add_f32 v226, v176, v177
    v_add_f32 v252, v174, v175
    v_add_f32 v227, v178, v179
    v_mov_b64 v[172:173], 0
    v_mov_b64 v[176:177], 0
    ds_add_f32 v203, v225
    ds_add_f32 v203, v226 offset:256
    ds_add_f32 v203, v252 offset:128
    ds_add_f32 v203, v227 offset:384
    v_mov_b64 v[174:175], 0
    v_mov_b64 v[178:179], 0
    s_mov_b64 exec, -1
    s_branch L_bk_68
L_fl_69:
    s_bfe_i32 exec_lo, s40, 0x10000
    s_bfe_i32 exec_hi, s41, 0x10000
    v_add_f32 v225, v172, v173
    v_add_f32 v226, v176, v177
    v_add_f32 v252, v174, v175
    v_add_f32 v227, v178, v179
    v_mov_b64 v[172:173], 0
    v_mov_b64 v[176:177], 0
    ds_add_f32 v196, v225
    ds_add_f32 v196, v226 offset:256
    ds_add_f32 v196, v252 offset:128
    ds_add_f32 v196, v227 offset:384
    v_mov_b64 v[174:175], 0
    v_mov_b64 v[178:179], 0
    s_mov_b64 exec, -1
    s_branch L_bk_70
L_fl_71:
    s_bfe_i32 exec_lo, s40, 0x10008
    s_bfe_i32 exec_hi, s41, 0x10008
    v_add_f32 v225, v172, v173
    v_add_f32 v226, v176, v177
    v_add_f32 v252, v174, v175
    v_add_f32 v227, v178, v179
    v_mov_b64 v[172:173], 0
    v_mov_b64 v[176:177], 0
    ds_add_f32 v197, v225
    ds_add_f32 v197, v226 offset:256
    ds_add_f32 v197, v252 offset:128
    ds_add_f32 v197, v227 offset:384
    v_mov_b64 v[174:175], 0
    v_mov_b64 v[178:179], 0
    s_mov_b64 exec, -1
    s_branch L_bk_72
L_fl_73:
    s_bfe_i32 exec_lo, s40, 0x10010
    s_bfe_i32 exec_hi, s41, 0x10010
    v_add_f32 v225, v172, v173
    v_add_f32 v226, v176, v177
    v_add_f32 v252, v174, v175
    v_add_f32 v227, v178, v179
    v_mov_b64 v[172:173], 0
    v_mov_b64 v[176:177], 0
    ds_add_f32 v198, v225
    ds_add_f32 v198, v226 offset:256
    ds_add_f32 v198, v252 offset:128
    ds_add_f32 v198, v227 offset:384
    v_mov_b64 v[174:175], 0
    v_mov_b64 v[178:179], 0
    s_mov_b64 exec, -1
    s_branch L_bk_74
L_fl_75:
    s_bfe_i32 exec_lo, s40, 0x10018
    s_bfe_i32 exec_hi, s41, 0x10018
    v_add_f32 v225, v172, v173
    v_add_f32 v226, v176, v177
    v_add_f32 v252, v174, v175
    v_add_f32 v227, v178, v179
    v_mov_b64 v[172:173], 0
    v_mov_b64 v[176:177], 0
    ds_add_f32 v199, v225
    ds_add_f32 v199, v226 offset:256
    ds_add_f32 v199, v252 offset:128
    ds_add_f32 v199, v227 offset:384
    v_mov_b64 v[174:175], 0
    v_mov_b64 v[178:179], 0
    s_mov_b64 exec, -1
    s_branch L_bk_76
L_fl_77:
    s_bfe_i32 exec_lo, s40, 0x10000
    s_bfe_i32 exec_hi, s41, 0x10000
    v_add_f32 v225, v172, v173
    v_add_f32 v226, v176, v177
    v_add_f32 v252, v174, v175
    v_add_f32 v227, v178, v179
    v_mov_b64 v[172:173], 0
    v_mov_b64 v[176:177], 0
    ds_add_f32 v196, v225
    ds_add_f32 v196, v226 offset:256
    ds_add_f32 v196, v252 offset:128
    ds_add_f32 v196, v227 offset:384
    v_mov_b64 v[174:175], 0
    v_mov_b64 v[178:179], 0
    s_mov_b64 exec, -1
    s_branch L_bk_78
L_fl_79:
    s_bfe_i32 exec_lo, s40, 0x10008
    s_bfe_i32 exec_hi, s41, 0x10008
    v_add_f32 v225, v172, v173
    v_add_f32 v226, v176, v177
    v_add_f32 v252, v174, v175
    v_add_f32 v227, v178, v179
    v_mov_b64 v[172:173], 0
    v_mov_b64 v[176:177], 0
    ds_add_f32 v197, v225
    ds_add_f32 v197, v226 offset:256
    ds_add_f32 v197, v252 offset:128
    ds_add_f32 v197, v227 offset:384
    v_mov_b64 v[174:175], 0
    v_mov_b64 v[178:179], 0
    s_mov_b64 exec, -1
    s_branch L_bk_80
L_fl_81:
    s_bfe_i32 exec_lo, s40, 0x10010
    s_bfe_i32 exec_hi, s41, 0x10010
    v_add_f32 v225, v172, v173
    v_add_f32 v226, v176, v177
    v_add_f32 v252, v174, v175
    v_add_f32 v227, v178, v179
    v_mov_b64 v[172:173], 0
    v_mov_b64 v[176:177], 0
    ds_add_f32 v198, v225
    ds_add_f32 v198, v226 offset:256
    ds_add_f32 v198, v252 offset:128
    ds_add_f32 v198, v227 offset:384
    v_mov_b64 v[174:175], 0
    v_mov_b64 v[178:179], 0
    s_mov_b64 exec, -1
    s_branch L_bk_82
L_fl_83:
    s_bfe_i32 exec_lo, s40, 0x10018
    s_bfe_i32 exec_hi, s41, 0x10018
    v_add_f32 v225, v172, v173
    v_add_f32 v226, v176, v177
    v_add_f32 v252, v174, v175
    v_add_f32 v227, v178, v179
    v_mov_b64 v[172:173], 0
    v_mov_b64 v[176:177], 0
    ds_add_f32 v199, v225
    ds_add_f32 v199, v226 offset:256
    ds_add_f32 v199, v252 offset:128
    ds_add_f32 v199, v227 offset:384
    v_mov_b64 v[174:175], 0
    v_mov_b64 v[178:179], 0
    s_mov_b64 exec, -1
    s_branch L_bk_84
L_fl_85:
    s_bfe_i32 exec_lo, s42, 0x10000
    s_bfe_i32 exec_hi, s43, 0x10000
    v_add_f32 v225, v172, v173
    v_add_f32 v226, v176, v177
    v_add_f32 v252, v174, v175
    v_add_f32 v227, v178, v179
    v_mov_b64 v[172:173], 0
    v_mov_b64 v[176:177], 0
    ds_add_f32 v200, v225
    ds_add_f32 v200, v226 offset:256
    ds_add_f32 v200, v252 offset:128
    ds_add_f32 v200, v227 offset:384
    v_mov_b64 v[174:175], 0
    v_mov_b64 v[178:179], 0
    s_mov_b64 exec, -1
    s_branch L_bk_86
L_fl_87:
    s_bfe_i32 exec_lo, s42, 0x10008
    s_bfe_i32 exec_hi, s43, 0x10008
    v_add_f32 v225, v172, v173
    v_add_f32 v226, v176, v177
    v_add_f32 v252, v174, v175
    v_add_f32 v227, v178, v179
    v_mov_b64 v[172:173], 0
    v_mov_b64 v[176:177], 0
    ds_add_f32 v201, v225
    ds_add_f32 v201, v226 offset:256
    ds_add_f32 v201, v252 offset:128
    ds_add_f32 v201, v227 offset:384
    v_mov_b64 v[174:175], 0
    v_mov_b64 v[178:179], 0
    s_mov_b64 exec, -1
    s_branch L_bk_88
L_fl_89:
    s_bfe_i32 exec_lo, s42, 0x10010
    s_bfe_i32 exec_hi, s43, 0x10010
    v_add_f32 v225, v172, v173
    v_add_f32 v226, v176, v177
    v_add_f32 v252, v174, v175
    v_add_f32 v227, v178, v179
    v_mov_b64 v[172:173], 0
    v_mov_b64 v[176:177], 0
    ds_add_f32 v202, v225
    ds_add_f32 v202, v226 offset:256
    ds_add_f32 v202, v252 offset:128
    ds_add_f32 v202, v227 offset:384
    v_mov_b64 v[174:175], 0
    v_mov_b64 v[178:179], 0
    s_mov_b64 exec, -1
    s_branch L_bk_90
L_fl_91:
    s_bfe_i32 exec_lo, s42, 0x10018
    s_bfe_i32 exec_hi, s43, 0x10018
    v_add_f32 v225, v172, v173
    v_add_f32 v226, v176, v177
    v_add_f32 v252, v174, v175
    v_add_f32 v227, v178, v179
    v_mov_b64 v[172:173], 0
    v_mov_b64 v[176:177], 0
    ds_add_f32 v203, v225
    ds_add_f32 v203, v226 offset:256
    ds_add_f32 v203, v252 offset:128
    ds_add_f32 v203, v227 offset:384
    v_mov_b64 v[174:175], 0
    v_mov_b64 v[178:179], 0
    s_mov_b64 exec, -1
    s_branch L_bk_92
K2_MDS:
    s_setprio 0
K2_SNEXT:
    s_waitcnt vmcnt(0) lgkmcnt(0)
    s_barrier
    s_add_u32 s31, s31, 1
    s_cmp_lt_u32 s31, s32
    s_cbranch_scc1 K2_SPASS
    s_mov_b32 s16, s8
    s_and_b32 s17, s9, 0xffff
    s_mov_b32 s18, 3200000
    s_mov_b32 s19, 0x20000
    s_mov_b32 s24, s4
    s_and_b32 s25, s5, 0xffff
    s_mov_b32 s26, 3200000
    s_mov_b32 s27, 0x20000
    s_mov_b32 s49, 784
    s_mov_b32 s38, 0x4e8637bd
    s_mov_b32 s39, 0x4e8637bd
    s_mov_b32 s48, 0xffff0000
    s_waitcnt vmcnt(0)
    v_and_b32 v108, 4, v0
    v_cmp_eq_u32 vcc, 0, v108
    v_mov_b32 v110, 0x03020c0c
    v_mov_b32 v109, 0x01000c0c
    v_cndmask_b32 v110, v110, v109, vcc
    v_mov_b32 v108, v0
    v_lshrrev_b32 v109, 3, v108
    v_and_b32 v108, 7, v108
    v_lshlrev_b32 v106, 5, v108
    v_mul_u32_u24 v104, s49, v109
    v_add_u32 v104, 20736, v104
    v_add_u32 v100, v104, v106
    v_and_b32 v111, 3, v108
    v_lshl_add_u32 v111, v111, 5, v104
    v_add_u32 v102, s29, v109
    v_lshlrev_b32 v102, 7, v102
    v_lshl_add_u32 v102, v108, 4, v102
    buffer_load_dwordx4 v[4:7], v102, s[24:27], 0 offen
    ds_read_b128 v[12:15], v111 offset:640
    ds_read_b128 v[16:19], v111 offset:656
    v_add_u32 v108, 512, v0
    v_lshrrev_b32 v109, 3, v108
    v_and_b32 v108, 7, v108
    v_lshlrev_b32 v107, 5, v108
    v_mul_u32_u24 v105, s49, v109
    v_add_u32 v105, 20736, v105
    v_add_u32 v101, v105, v107
    v_and_b32 v112, 3, v108
    v_lshl_add_u32 v112, v112, 5, v105
    v_add_u32 v103, s29, v109
    v_lshlrev_b32 v103, 7, v103
    v_lshl_add_u32 v103, v108, 4, v103
    v_cmp_gt_u32 s[54:55], s30, v109
    s_nop 3
    s_mov_b64 exec, s[54:55]
    s_cbranch_execz K2_NS2S
    buffer_load_dwordx4 v[8:11], v103, s[24:27], 0 offen
    ds_read_b128 v[20:23], v112 offset:640
    ds_read_b128 v[24:27], v112 offset:656
K2_NS2S:
    s_mov_b64 exec, -1
    s_waitcnt lgkmcnt(0)
    s_barrier
    ds_read_b128 v[28:31], v100
    ds_read_b128 v[32:35], v100 offset:16
    ds_read_b128 v[36:39], v100 offset:256
    ds_read_b128 v[40:43], v100 offset:272
    s_mov_b64 exec, s[54:55]
    s_cbranch_execz K2_ONES
    ds_read_b128 v[60:63], v101
    ds_read_b128 v[64:67], v101 offset:16
    ds_read_b128 v[68:71], v101 offset:256
    ds_read_b128 v[72:75], v101 offset:272
    s_mov_b64 exec, -1
    s_waitcnt vmcnt(0) lgkmcnt(4)
    v_pk_add_f32 v[28:29], v[28:29], s[38:39]
    v_pk_add_f32 v[30:31], v[30:31], s[38:39]
    v_pk_add_f32 v[32:33], v[32:33], s[38:39]
    v_pk_add_f32 v[34:35], v[34:35], s[38:39]
    v_rcp_f32 v28, v28
    v_rcp_f32 v29, v29
    v_rcp_f32 v30, v30
    v_rcp_f32 v31, v31
    v_rcp_f32 v32, v32
    v_rcp_f32 v33, v33
    v_rcp_f32 v34, v34
    v_rcp_f32 v35, v35
    v_perm_b32 v44, v12, v12, v110
    v_perm_b32 v45, v13, v13, v110
    v_perm_b32 v46, v14, v14, v110
    v_perm_b32 v47, v15, v15, v110
    v_perm_b32 v48, v16, v16, v110
    v_perm_b32 v49, v17, v17, v110
    v_perm_b32 v50, v18, v18, v110
    v_perm_b32 v51, v19, v19, v110
    v_pk_fma_f32 v[36:37], v[36:37], v[28:29], v[44:45]
    v_pk_fma_f32 v[38:39], v[38:39], v[30:31], v[46:47]
    v_pk_fma_f32 v[40:41], v[40:41], v[32:33], v[48:49]
    v_pk_fma_f32 v[42:43], v[42:43], v[34:35], v[50:51]
    v_max_f32 v36, 0, v36
    v_max_f32 v37, 0, v37
    v_max_f32 v38, 0, v38
    v_max_f32 v39, 0, v39
    v_max_f32 v40, 0, v40
    v_max_f32 v41, 0, v41
    v_max_f32 v42, 0, v42
    v_max_f32 v43, 0, v43
    v_lshlrev_b32 v44, 16, v4
    v_and_b32 v45, s48, v4
    v_lshlrev_b32 v46, 16, v5
    v_and_b32 v47, s48, v5
    v_lshlrev_b32 v48, 16, v6
    v_and_b32 v49, s48, v6
    v_lshlrev_b32 v50, 16, v7
    v_and_b32 v51, s48, v7
    v_pk_add_f32 v[36:37], v[36:37], v[44:45]
    v_pk_add_f32 v[38:39], v[38:39], v[46:47]
    v_pk_add_f32 v[40:41], v[40:41], v[48:49]
    v_pk_add_f32 v[42:43], v[42:43], v[50:51]
    v_cvt_pk_bf16_f32 v92, v36, v37
    v_cvt_pk_bf16_f32 v93, v38, v39
    v_cvt_pk_bf16_f32 v94, v40, v41
    v_cvt_pk_bf16_f32 v95, v42, v43
    buffer_store_dwordx4 v[92:95], v102, s[16:19], 0 offen sc1
    s_mov_b64 exec, s[54:55]
    s_waitcnt lgkmcnt(0)
    v_pk_add_f32 v[60:61], v[60:61], s[38:39]
    v_pk_add_f32 v[62:63], v[62:63], s[38:39]
    v_pk_add_f32 v[64:65], v[64:65], s[38:39]
    v_pk_add_f32 v[66:67], v[66:67], s[38:39]
    v_rcp_f32 v60, v60
    v_rcp_f32 v61, v61
    v_rcp_f32 v62, v62
    v_rcp_f32 v63, v63
    v_rcp_f32 v64, v64
    v_rcp_f32 v65, v65
    v_rcp_f32 v66, v66
    v_rcp_f32 v67, v67
    v_perm_b32 v76, v20, v20, v110
    v_perm_b32 v77, v21, v21, v110
    v_perm_b32 v78, v22, v22, v110
    v_perm_b32 v79, v23, v23, v110
    v_perm_b32 v80, v24, v24, v110
    v_perm_b32 v81, v25, v25, v110
    v_perm_b32 v82, v26, v26, v110
    v_perm_b32 v83, v27, v27, v110
    v_pk_fma_f32 v[68:69], v[68:69], v[60:61], v[76:77]
    v_pk_fma_f32 v[70:71], v[70:71], v[62:63], v[78:79]
    v_pk_fma_f32 v[72:73], v[72:73], v[64:65], v[80:81]
    v_pk_fma_f32 v[74:75], v[74:75], v[66:67], v[82:83]
    v_max_f32 v68, 0, v68
    v_max_f32 v69, 0, v69
    v_max_f32 v70, 0, v70
    v_max_f32 v71, 0, v71
    v_max_f32 v72, 0, v72
    v_max_f32 v73, 0, v73
    v_max_f32 v74, 0, v74
    v_max_f32 v75, 0, v75
    v_lshlrev_b32 v76, 16, v8
    v_and_b32 v77, s48, v8
    v_lshlrev_b32 v78, 16, v9
    v_and_b32 v79, s48, v9
    v_lshlrev_b32 v80, 16, v10
    v_and_b32 v81, s48, v10
    v_lshlrev_b32 v82, 16, v11
    v_and_b32 v83, s48, v11
    v_pk_add_f32 v[68:69], v[68:69], v[76:77]
    v_pk_add_f32 v[70:71], v[70:71], v[78:79]
    v_pk_add_f32 v[72:73], v[72:73], v[80:81]
    v_pk_add_f32 v[74:75], v[74:75], v[82:83]
    v_cvt_pk_bf16_f32 v96, v68, v69
    v_cvt_pk_bf16_f32 v97, v70, v71
    v_cvt_pk_bf16_f32 v98, v72, v73
    v_cvt_pk_bf16_f32 v99, v74, v75
    buffer_store_dwordx4 v[96:99], v103, s[16:19], 0 offen sc1
    s_branch K2_FINS
K2_ONES:
    s_mov_b64 exec, -1
    s_waitcnt vmcnt(0) lgkmcnt(0)
    v_pk_add_f32 v[28:29], v[28:29], s[38:39]
    v_pk_add_f32 v[30:31], v[30:31], s[38:39]
    v_pk_add_f32 v[32:33], v[32:33], s[38:39]
    v_pk_add_f32 v[34:35], v[34:35], s[38:39]
    v_rcp_f32 v28, v28
    v_rcp_f32 v29, v29
    v_rcp_f32 v30, v30
    v_rcp_f32 v31, v31
    v_rcp_f32 v32, v32
    v_rcp_f32 v33, v33
    v_rcp_f32 v34, v34
    v_rcp_f32 v35, v35
    v_perm_b32 v44, v12, v12, v110
    v_perm_b32 v45, v13, v13, v110
    v_perm_b32 v46, v14, v14, v110
    v_perm_b32 v47, v15, v15, v110
    v_perm_b32 v48, v16, v16, v110
    v_perm_b32 v49, v17, v17, v110
    v_perm_b32 v50, v18, v18, v110
    v_perm_b32 v51, v19, v19, v110
    v_pk_fma_f32 v[36:37], v[36:37], v[28:29], v[44:45]
    v_pk_fma_f32 v[38:39], v[38:39], v[30:31], v[46:47]
    v_pk_fma_f32 v[40:41], v[40:41], v[32:33], v[48:49]
    v_pk_fma_f32 v[42:43], v[42:43], v[34:35], v[50:51]
    v_max_f32 v36, 0, v36
    v_max_f32 v37, 0, v37
    v_max_f32 v38, 0, v38
    v_max_f32 v39, 0, v39
    v_max_f32 v40, 0, v40
    v_max_f32 v41, 0, v41
    v_max_f32 v42, 0, v42
    v_max_f32 v43, 0, v43
    v_lshlrev_b32 v44, 16, v4
    v_and_b32 v45, s48, v4
    v_lshlrev_b32 v46, 16, v5
    v_and_b32 v47, s48, v5
    v_lshlrev_b32 v48, 16, v6
    v_and_b32 v49, s48, v6
    v_lshlrev_b32 v50, 16, v7
    v_and_b32 v51, s48, v7
    v_pk_add_f32 v[36:37], v[36:37], v[44:45]
    v_pk_add_f32 v[38:39], v[38:39], v[46:47]
    v_pk_add_f32 v[40:41], v[40:41], v[48:49]
    v_pk_add_f32 v[42:43], v[42:43], v[50:51]
    v_cvt_pk_bf16_f32 v92, v36, v37
    v_cvt_pk_bf16_f32 v93, v38, v39
    v_cvt_pk_bf16_f32 v94, v40, v41
    v_cvt_pk_bf16_f32 v95, v42, v43
    buffer_store_dwordx4 v[92:95], v102, s[16:19], 0 offen sc1
K2_FINS:
    s_waitcnt vmcnt(0)
K2_END:
    s_endpgm
.section .rodata,"a"
.p2align 6
.amdhsa_kernel gs_part_kernel
  .amdhsa_next_free_vgpr 60
  .amdhsa_next_free_sgpr 60
  .amdhsa_accum_offset 60
  .amdhsa_group_segment_fixed_size 0
  .amdhsa_kernarg_size 96
  .amdhsa_user_sgpr_count 2
  .amdhsa_user_sgpr_kernarg_segment_ptr 1
  .amdhsa_system_sgpr_workgroup_id_x 1
  .amdhsa_float_denorm_mode_32 3
.end_amdhsa_kernel
.p2align 6
.amdhsa_kernel gs_main_kernel
  .amdhsa_next_free_vgpr 256
  .amdhsa_next_free_sgpr 96
  .amdhsa_accum_offset 256
  .amdhsa_group_segment_fixed_size 0
  .amdhsa_kernarg_size 96
  .amdhsa_user_sgpr_count 2
  .amdhsa_user_sgpr_kernarg_segment_ptr 1
  .amdhsa_system_sgpr_workgroup_id_x 1
  .amdhsa_float_denorm_mode_32 3
.end_amdhsa_kernel
```
